```python
import torch

def _softmax(x, axis=-1):
    return torch.softmax(x, dim=axis)
def _gelu(x):
    return torch.nn.functional.gelu(x, approximate="tanh")
def _silu(x):
    return torch.nn.functional.silu(x)
def _sigmoid(x):
    return torch.sigmoid(x)
def _layernorm(x, axis=-1, eps=1e-5):
    m = x.mean(dim=axis, keepdim=True)
    v = x.var(dim=axis, keepdim=True, unbiased=False)
    return (x - m) / torch.sqrt(v + eps)
def _scatter_add(tgt, idx, src, axis=0):
    return tgt.clone().index_add_(axis, idx, src)
def _segment_sum(src, seg, n):
    out = torch.zeros((n,) + src.shape[1:], dtype=src.dtype)
    return out.index_add_(0, seg, src)
def _pad(x, pw):
    flat = tuple(v for pair in reversed(pw) for v in pair)
    return torch.nn.functional.pad(x, flat)

kernel_name = 'interleave_layers__sliding_block__swiglu_ffn__prompt'

def setup_inputs():

    _w = (lambda a: (lambda t: t.to(torch.bfloat16) if t.is_floating_point() else t)(torch.as_tensor(a)))
    def _A_setup():
        B, S, D = 1, 2048, 512
        return {
            "x": _w((lambda *s: torch.randn(*s, dtype=torch.bfloat16) * 0.05)(B, S, D)),
            "wqkv": _w((lambda *s: torch.randn(*s, dtype=torch.bfloat16) * 0.05)(D, 3 * D)),
            "wo": _w((lambda *s: torch.randn(*s, dtype=torch.bfloat16) * 0.05)(D, D)),
        }
    _A_in = _A_setup()

    def _B_setup():
        B, S, D, F = 1, 2048, 512, 1792
        return {
            "x": _w((lambda *s: torch.randn(*s, dtype=torch.bfloat16) * 0.05)(B, S, D)),
            "w_gate": _w((lambda *s: torch.randn(*s, dtype=torch.bfloat16) * 0.05)(D, F)),
            "w_up": _w((lambda *s: torch.randn(*s, dtype=torch.bfloat16) * 0.05)(D, F)),
            "w_down": _w((lambda *s: torch.randn(*s, dtype=torch.bfloat16) * 0.05)(F, D)),
        }
    _B_in = _B_setup()

    return {
        "A_x": _A_in["x"],
        "A_wqkv": _A_in["wqkv"],
        "A_wo": _A_in["wo"],
        "B_x": _B_in["x"],
        "B_w_gate": _B_in["w_gate"],
        "B_w_up": _B_in["w_up"],
        "B_w_down": _B_in["w_down"],
    }

def reference(A_x, A_wqkv, A_wo, B_x, B_w_gate, B_w_up, B_w_down):
    def _A_ref(x, wqkv, wo):
        B, S, D = x.shape
        H = 32; Dh = D // H; W = 256
        qkv = (lambda x, *d: x.permute(*d))((x @ wqkv).reshape(B, S, 3, H, Dh), 2, 0, 3, 1, 4)
        q, k, v = qkv[0], qkv[1], qkv[2]
        scores = torch.einsum("bhqd,bhkd->bhqk", q, k) * (Dh ** -0.5)
        idx = torch.arange(S)
        mask = (idx[:, None] - idx[None, :] >= 0) & (idx[:, None] - idx[None, :] < W)
        scores = torch.where(mask[None, None], scores, -1e9)
        p = _softmax(scores, axis=-1)
        o = torch.einsum("bhqk,bhkd->bhqd", p, v)
        return (lambda x, *d: x.permute(*d))(o, 0, 2, 1, 3).reshape(B, S, D) @ wo

    def _B_ref(x, w_gate, w_up, w_down):
        g = _silu(x @ w_gate)
        u = x @ w_up
        return (g * u) @ w_down

    x = A_x
    x = x + _A_ref(_layernorm(x, axis=-1), A_wqkv, A_wo)
    x = x + _B_ref(_layernorm(x, axis=-1), B_w_gate, B_w_up, B_w_down)
    x = x + _A_ref(_layernorm(x, axis=-1), A_wqkv, A_wo)
    x = x + _B_ref(_layernorm(x, axis=-1), B_w_gate, B_w_up, B_w_down)
    return x
```

```asm
; @launch kernel=prep_kernel grid=(848,1,1) block=(64,1,1) lds=16384
; @launch kernel=main_kernel grid=(256,1,1) block=(512,1,1) lds=163840
.amdgcn_target "amdgcn-amd-amdhsa--gfx950"
.text
.globl prep_kernel
.p2align 8
.type prep_kernel,@function
prep_kernel:
  s_cmp_ge_u32 s2, 848
  s_cbranch_scc1 L_prep_end
  s_load_dwordx16 s[16:31], s[0:1], 0
  s_load_dwordx2 s[32:33], s[0:1], 72
  v_and_b32 v3, 31, v0
  v_lshrrev_b32 v4, 5, v0
  v_lshlrev_b32 v2, 4, v0
  s_mov_b32 s53, 0x3f803f80
  s_waitcnt lgkmcnt(0)
  s_mov_b32 s36, s32
  s_mov_b32 s37, s33
  s_mov_b32 s38, 0x10000000
  s_mov_b32 s39, 0x20000
  s_mov_b32 s43, 0x20000
  s_cmp_ge_u32 s2, 848
  s_cbranch_scc1 L_prep_touch
  s_cmp_ge_u32 s2, 720
  s_cbranch_scc1 L_prep_zero
  s_cmp_ge_u32 s2, 464
  s_cbranch_scc1 L_prep_x
  s_mov_b32 s47, 256
  s_mov_b32 s48, 0
  s_mov_b32 s50, 128
  s_mov_b32 s59, 0
  s_cmp_lt_u32 s2, 96
  s_cbranch_scc0 L_prep_n1
  s_mov_b32 s40, s18
  s_mov_b32 s41, s19
  s_mov_b32 s42, 1572864
  s_mov_b32 s44, 3072
  s_lshr_b32 s45, s2, 2
  s_and_b32 s52, s2, 3
  s_lshr_b32 s55, s45, 3
  s_and_b32 s56, s45, 7
  s_mul_i32 s56, s56, 6
  s_add_u32 s56, s56, s55
  s_lshl_b32 s46, s56, 15
  s_add_u32 s46, s46, 0x3400000
  s_mov_b32 s51, 98304
  s_lshl_b32 s49, s56, 10
  s_add_u32 s49, s49, 0x3580000
  s_mov_b32 s54, 3072
  s_branch L_prep_strip
L_prep_n1:
  s_cmp_lt_u32 s2, 320
  s_cbranch_scc0 L_prep_n2
  s_mov_b32 s42, 1835008
  s_mov_b32 s44, 3584
  s_mov_b32 s47, 32768
  s_mov_b32 s50, 1024
  s_sub_u32 s55, s2, 96
  s_mov_b32 s40, s24
  s_mov_b32 s41, s25
  s_cmp_lt_u32 s2, 208
  s_cbranch_scc1 L_prep_gu
  s_sub_u32 s55, s2, 208
  s_mov_b32 s40, s26
  s_mov_b32 s41, s27
  s_mov_b32 s48, 256
L_prep_gu:
  s_lshr_b32 s45, s55, 2
  s_and_b32 s52, s55, 3
  s_lshl_b32 s46, s45, 17
  s_add_u32 s46, s46, 0x80000
  s_mov_b32 s51, 65536
  s_lshl_b32 s49, s45, 12
  s_add_u32 s49, s49, 0x5c0000
  s_mov_b32 s54, 2048
  s_branch L_prep_strip
L_prep_n2:
  s_mov_b32 s44, 1024
  s_mov_b32 s49, 0x5dc000
  s_mov_b32 s54, 1024
  s_cmp_lt_u32 s2, 352
  s_cbranch_scc0 L_prep_n3
  s_mov_b32 s40, s20
  s_mov_b32 s41, s21
  s_mov_b32 s42, 524288
  s_sub_u32 s55, s2, 320
  s_lshr_b32 s45, s55, 2
  s_and_b32 s52, s55, 3
  s_lshl_b32 s46, s45, 16
  s_add_u32 s46, s46, 0x0
  s_mov_b32 s51, 32768
  s_branch L_prep_strip
L_prep_n3:
  s_mov_b32 s40, s28
  s_mov_b32 s41, s29
  s_mov_b32 s42, 1835008
  s_sub_u32 s55, s2, 352
  s_and_b32 s45, s55, 7
  s_lshr_b32 s52, s55, 3
  s_mov_b32 s59, 1
  s_mul_i32 s46, s45, 229376
  s_add_u32 s46, s46, 0x400000
  s_mov_b32 s51, 114688
L_prep_strip:
  v_lshrrev_b32 v5, 3, v0
  v_mul_lo_u32 v5, v5, s44
  v_and_b32 v6, 7, v0
  v_lshl_add_u32 v5, v6, 4, v5
  s_lshl_b32 s55, s52, 7
  s_mul_i32 s55, s55, s44
  s_lshl_b32 s56, s45, 7
  s_add_u32 s55, s55, s56
  s_lshl_b32 s56, s44, 3
  s_mov_b32 m0, 0
  s_nop 0
  buffer_load_dwordx4 v5, s[40:43], s55 offen lds
  s_mov_b32 m0, 1024
  s_add_u32 s55, s55, s56
  buffer_load_dwordx4 v5, s[40:43], s55 offen lds
  s_mov_b32 m0, 2048
  s_add_u32 s55, s55, s56
  buffer_load_dwordx4 v5, s[40:43], s55 offen lds
  s_mov_b32 m0, 3072
  s_add_u32 s55, s55, s56
  buffer_load_dwordx4 v5, s[40:43], s55 offen lds
  s_mov_b32 m0, 4096
  s_add_u32 s55, s55, s56
  buffer_load_dwordx4 v5, s[40:43], s55 offen lds
  s_mov_b32 m0, 5120
  s_add_u32 s55, s55, s56
  buffer_load_dwordx4 v5, s[40:43], s55 offen lds
  s_mov_b32 m0, 6144
  s_add_u32 s55, s55, s56
  buffer_load_dwordx4 v5, s[40:43], s55 offen lds
  s_mov_b32 m0, 7168
  s_add_u32 s55, s55, s56
  buffer_load_dwordx4 v5, s[40:43], s55 offen lds
  s_mov_b32 m0, 8192
  s_add_u32 s55, s55, s56
  buffer_load_dwordx4 v5, s[40:43], s55 offen lds
  s_mov_b32 m0, 9216
  s_add_u32 s55, s55, s56
  buffer_load_dwordx4 v5, s[40:43], s55 offen lds
  s_mov_b32 m0, 10240
  s_add_u32 s55, s55, s56
  buffer_load_dwordx4 v5, s[40:43], s55 offen lds
  s_mov_b32 m0, 11264
  s_add_u32 s55, s55, s56
  buffer_load_dwordx4 v5, s[40:43], s55 offen lds
  s_mov_b32 m0, 12288
  s_add_u32 s55, s55, s56
  buffer_load_dwordx4 v5, s[40:43], s55 offen lds
  s_mov_b32 m0, 13312
  s_add_u32 s55, s55, s56
  buffer_load_dwordx4 v5, s[40:43], s55 offen lds
  s_mov_b32 m0, 14336
  s_add_u32 s55, s55, s56
  buffer_load_dwordx4 v5, s[40:43], s55 offen lds
  s_mov_b32 m0, 15360
  s_add_u32 s55, s55, s56
  buffer_load_dwordx4 v5, s[40:43], s55 offen lds
  v_bfe_u32 v7, v0, 2, 2
  v_lshl_add_u32 v7, v4, 2, v7
  v_lshlrev_b32 v7, 7, v7
  v_bfe_u32 v8, v0, 4, 1
  v_lshl_add_u32 v7, v8, 5, v7
  v_and_b32 v8, 3, v0
  v_lshl_add_u32 v7, v8, 3, v7
  v_lshrrev_b32 v9, 4, v3
  v_and_b32 v8, 15, v3
  v_lshlrev_b32 v8, 4, v8
  v_mul_lo_u32 v6, v9, s47
  v_add_u32 v6, v6, v8
  v_lshl_add_u32 v6, v4, 9, v6
  v_add_u32 v6, s48, v6
  v_mul_lo_u32 v10, v9, s50
  v_lshrrev_b32 v8, 1, v8
  v_add_u32 v10, v10, v8
  s_and_b32 s57, s52, 3
  s_lshl_b32 s57, s57, 8
  s_lshr_b32 s58, s48, 1
  s_add_u32 s57, s57, s58
  s_add_u32 s57, s57, s49
  v_add_u32 v10, s57, v10
  v_mov_b32 v11, 0
  v_mov_b32 v12, 0
  s_lshl_b32 s57, s52, 3
  s_add_u32 s57, s57, 0
  s_mul_i32 s58, s57, 9363
  s_lshr_b32 s58, s58, 16
  s_mul_i32 s60, s58, 7
  s_sub_u32 s60, s57, s60
  s_lshl_b32 s60, s60, 4
  s_add_u32 s60, s60, s58
  s_cmp_eq_u32 s59, 1
  s_cselect_b32 s57, s60, s57
  s_lshl_b32 s57, s57, 10
  s_add_u32 s64, s57, s46
  s_add_u32 s65, s64, s51
  s_lshl_b32 s57, s52, 3
  s_add_u32 s57, s57, 1
  s_mul_i32 s58, s57, 9363
  s_lshr_b32 s58, s58, 16
  s_mul_i32 s60, s58, 7
  s_sub_u32 s60, s57, s60
  s_lshl_b32 s60, s60, 4
  s_add_u32 s60, s60, s58
  s_cmp_eq_u32 s59, 1
  s_cselect_b32 s57, s60, s57
  s_lshl_b32 s57, s57, 10
  s_add_u32 s66, s57, s46
  s_add_u32 s67, s66, s51
  s_lshl_b32 s57, s52, 3
  s_add_u32 s57, s57, 2
  s_mul_i32 s58, s57, 9363
  s_lshr_b32 s58, s58, 16
  s_mul_i32 s60, s58, 7
  s_sub_u32 s60, s57, s60
  s_lshl_b32 s60, s60, 4
  s_add_u32 s60, s60, s58
  s_cmp_eq_u32 s59, 1
  s_cselect_b32 s57, s60, s57
  s_lshl_b32 s57, s57, 10
  s_add_u32 s68, s57, s46
  s_add_u32 s69, s68, s51
  s_lshl_b32 s57, s52, 3
  s_add_u32 s57, s57, 3
  s_mul_i32 s58, s57, 9363
  s_lshr_b32 s58, s58, 16
  s_mul_i32 s60, s58, 7
  s_sub_u32 s60, s57, s60
  s_lshl_b32 s60, s60, 4
  s_add_u32 s60, s60, s58
  s_cmp_eq_u32 s59, 1
  s_cselect_b32 s57, s60, s57
  s_lshl_b32 s57, s57, 10
  s_add_u32 s70, s57, s46
  s_add_u32 s71, s70, s51
  s_lshl_b32 s57, s52, 3
  s_add_u32 s57, s57, 4
  s_mul_i32 s58, s57, 9363
  s_lshr_b32 s58, s58, 16
  s_mul_i32 s60, s58, 7
  s_sub_u32 s60, s57, s60
  s_lshl_b32 s60, s60, 4
  s_add_u32 s60, s60, s58
  s_cmp_eq_u32 s59, 1
  s_cselect_b32 s57, s60, s57
  s_lshl_b32 s57, s57, 10
  s_add_u32 s72, s57, s46
  s_add_u32 s73, s72, s51
  s_lshl_b32 s57, s52, 3
  s_add_u32 s57, s57, 5
  s_mul_i32 s58, s57, 9363
  s_lshr_b32 s58, s58, 16
  s_mul_i32 s60, s58, 7
  s_sub_u32 s60, s57, s60
  s_lshl_b32 s60, s60, 4
  s_add_u32 s60, s60, s58
  s_cmp_eq_u32 s59, 1
  s_cselect_b32 s57, s60, s57
  s_lshl_b32 s57, s57, 10
  s_add_u32 s74, s57, s46
  s_add_u32 s75, s74, s51
  s_lshl_b32 s57, s52, 3
  s_add_u32 s57, s57, 6
  s_mul_i32 s58, s57, 9363
  s_lshr_b32 s58, s58, 16
  s_mul_i32 s60, s58, 7
  s_sub_u32 s60, s57, s60
  s_lshl_b32 s60, s60, 4
  s_add_u32 s60, s60, s58
  s_cmp_eq_u32 s59, 1
  s_cselect_b32 s57, s60, s57
  s_lshl_b32 s57, s57, 10
  s_add_u32 s76, s57, s46
  s_add_u32 s77, s76, s51
  s_lshl_b32 s57, s52, 3
  s_add_u32 s57, s57, 7
  s_mul_i32 s58, s57, 9363
  s_lshr_b32 s58, s58, 16
  s_mul_i32 s60, s58, 7
  s_sub_u32 s60, s57, s60
  s_lshl_b32 s60, s60, 4
  s_add_u32 s60, s60, s58
  s_cmp_eq_u32 s59, 1
  s_cselect_b32 s57, s60, s57
  s_lshl_b32 s57, s57, 10
  s_add_u32 s78, s57, s46
  s_add_u32 s79, s78, s51
  s_waitcnt vmcnt(14)
  ds_read_b64_tr_b16 v[16:17], v7 offset:0
  ds_read_b64_tr_b16 v[18:19], v7 offset:1024
  ds_read_b64_tr_b16 v[20:21], v7 offset:64
  ds_read_b64_tr_b16 v[22:23], v7 offset:1088
  s_waitcnt vmcnt(12)
  ds_read_b64_tr_b16 v[24:25], v7 offset:2048
  ds_read_b64_tr_b16 v[26:27], v7 offset:3072
  ds_read_b64_tr_b16 v[28:29], v7 offset:2112
  ds_read_b64_tr_b16 v[30:31], v7 offset:3136
  s_waitcnt vmcnt(10)
  ds_read_b64_tr_b16 v[32:33], v7 offset:4096
  ds_read_b64_tr_b16 v[34:35], v7 offset:5120
  ds_read_b64_tr_b16 v[36:37], v7 offset:4160
  ds_read_b64_tr_b16 v[38:39], v7 offset:5184
  s_waitcnt vmcnt(8)
  ds_read_b64_tr_b16 v[40:41], v7 offset:6144
  ds_read_b64_tr_b16 v[42:43], v7 offset:7168
  ds_read_b64_tr_b16 v[44:45], v7 offset:6208
  ds_read_b64_tr_b16 v[46:47], v7 offset:7232
  s_waitcnt vmcnt(6)
  ds_read_b64_tr_b16 v[48:49], v7 offset:8192
  ds_read_b64_tr_b16 v[50:51], v7 offset:9216
  ds_read_b64_tr_b16 v[52:53], v7 offset:8256
  ds_read_b64_tr_b16 v[54:55], v7 offset:9280
  s_waitcnt vmcnt(4)
  ds_read_b64_tr_b16 v[56:57], v7 offset:10240
  ds_read_b64_tr_b16 v[58:59], v7 offset:11264
  ds_read_b64_tr_b16 v[60:61], v7 offset:10304
  ds_read_b64_tr_b16 v[62:63], v7 offset:11328
  s_waitcnt vmcnt(2)
  ds_read_b64_tr_b16 v[64:65], v7 offset:12288
  ds_read_b64_tr_b16 v[66:67], v7 offset:13312
  ds_read_b64_tr_b16 v[68:69], v7 offset:12352
  ds_read_b64_tr_b16 v[70:71], v7 offset:13376
  s_waitcnt vmcnt(0)
  ds_read_b64_tr_b16 v[72:73], v7 offset:14336
  ds_read_b64_tr_b16 v[74:75], v7 offset:15360
  ds_read_b64_tr_b16 v[76:77], v7 offset:14400
  ds_read_b64_tr_b16 v[78:79], v7 offset:15424
  s_waitcnt lgkmcnt(15)
  buffer_store_dwordx4 v[16:19], v6, s[36:39], s64 offen
  v_dot2_f32_bf16 v11, v16, s53, v11
  v_dot2_f32_bf16 v11, v17, s53, v11
  v_dot2_f32_bf16 v11, v18, s53, v11
  v_dot2_f32_bf16 v11, v19, s53, v11
  buffer_store_dwordx4 v[20:23], v6, s[36:39], s65 offen
  v_dot2_f32_bf16 v12, v20, s53, v12
  v_dot2_f32_bf16 v12, v21, s53, v12
  v_dot2_f32_bf16 v12, v22, s53, v12
  v_dot2_f32_bf16 v12, v23, s53, v12
  buffer_store_dwordx4 v[24:27], v6, s[36:39], s66 offen
  v_dot2_f32_bf16 v11, v24, s53, v11
  v_dot2_f32_bf16 v11, v25, s53, v11
  v_dot2_f32_bf16 v11, v26, s53, v11
  v_dot2_f32_bf16 v11, v27, s53, v11
  buffer_store_dwordx4 v[28:31], v6, s[36:39], s67 offen
  v_dot2_f32_bf16 v12, v28, s53, v12
  v_dot2_f32_bf16 v12, v29, s53, v12
  v_dot2_f32_bf16 v12, v30, s53, v12
  v_dot2_f32_bf16 v12, v31, s53, v12
  buffer_store_dwordx4 v[32:35], v6, s[36:39], s68 offen
  v_dot2_f32_bf16 v11, v32, s53, v11
  v_dot2_f32_bf16 v11, v33, s53, v11
  v_dot2_f32_bf16 v11, v34, s53, v11
  v_dot2_f32_bf16 v11, v35, s53, v11
  buffer_store_dwordx4 v[36:39], v6, s[36:39], s69 offen
  v_dot2_f32_bf16 v12, v36, s53, v12
  v_dot2_f32_bf16 v12, v37, s53, v12
  v_dot2_f32_bf16 v12, v38, s53, v12
  v_dot2_f32_bf16 v12, v39, s53, v12
  buffer_store_dwordx4 v[40:43], v6, s[36:39], s70 offen
  v_dot2_f32_bf16 v11, v40, s53, v11
  v_dot2_f32_bf16 v11, v41, s53, v11
  v_dot2_f32_bf16 v11, v42, s53, v11
  v_dot2_f32_bf16 v11, v43, s53, v11
  buffer_store_dwordx4 v[44:47], v6, s[36:39], s71 offen
  v_dot2_f32_bf16 v12, v44, s53, v12
  v_dot2_f32_bf16 v12, v45, s53, v12
  v_dot2_f32_bf16 v12, v46, s53, v12
  v_dot2_f32_bf16 v12, v47, s53, v12
  s_waitcnt lgkmcnt(12)
  buffer_store_dwordx4 v[48:51], v6, s[36:39], s72 offen
  v_dot2_f32_bf16 v11, v48, s53, v11
  v_dot2_f32_bf16 v11, v49, s53, v11
  v_dot2_f32_bf16 v11, v50, s53, v11
  v_dot2_f32_bf16 v11, v51, s53, v11
  buffer_store_dwordx4 v[52:55], v6, s[36:39], s73 offen
  v_dot2_f32_bf16 v12, v52, s53, v12
  v_dot2_f32_bf16 v12, v53, s53, v12
  v_dot2_f32_bf16 v12, v54, s53, v12
  v_dot2_f32_bf16 v12, v55, s53, v12
  s_waitcnt lgkmcnt(8)
  buffer_store_dwordx4 v[56:59], v6, s[36:39], s74 offen
  v_dot2_f32_bf16 v11, v56, s53, v11
  v_dot2_f32_bf16 v11, v57, s53, v11
  v_dot2_f32_bf16 v11, v58, s53, v11
  v_dot2_f32_bf16 v11, v59, s53, v11
  buffer_store_dwordx4 v[60:63], v6, s[36:39], s75 offen
  v_dot2_f32_bf16 v12, v60, s53, v12
  v_dot2_f32_bf16 v12, v61, s53, v12
  v_dot2_f32_bf16 v12, v62, s53, v12
  v_dot2_f32_bf16 v12, v63, s53, v12
  s_waitcnt lgkmcnt(4)
  buffer_store_dwordx4 v[64:67], v6, s[36:39], s76 offen
  v_dot2_f32_bf16 v11, v64, s53, v11
  v_dot2_f32_bf16 v11, v65, s53, v11
  v_dot2_f32_bf16 v11, v66, s53, v11
  v_dot2_f32_bf16 v11, v67, s53, v11
  buffer_store_dwordx4 v[68:71], v6, s[36:39], s77 offen
  v_dot2_f32_bf16 v12, v68, s53, v12
  v_dot2_f32_bf16 v12, v69, s53, v12
  v_dot2_f32_bf16 v12, v70, s53, v12
  v_dot2_f32_bf16 v12, v71, s53, v12
  s_waitcnt lgkmcnt(0)
  buffer_store_dwordx4 v[72:75], v6, s[36:39], s78 offen
  v_dot2_f32_bf16 v11, v72, s53, v11
  v_dot2_f32_bf16 v11, v73, s53, v11
  v_dot2_f32_bf16 v11, v74, s53, v11
  v_dot2_f32_bf16 v11, v75, s53, v11
  buffer_store_dwordx4 v[76:79], v6, s[36:39], s79 offen
  v_dot2_f32_bf16 v12, v76, s53, v12
  v_dot2_f32_bf16 v12, v77, s53, v12
  v_dot2_f32_bf16 v12, v78, s53, v12
  v_dot2_f32_bf16 v12, v79, s53, v12
  s_nop 2
  v_mov_b32 v13, v11
  v_mov_b32 v14, v12
  s_nop 1
  v_permlane32_swap_b32 v11, v13
  v_permlane32_swap_b32 v12, v14
  s_nop 1
  v_add_f32 v11, v11, v13
  v_add_f32 v12, v12, v14
  v_cvt_pk_bf16_f32 v13, v11, v11
  v_lshlrev_b32 v13, 16, v13
  v_sub_f32 v13, v11, v13
  v_cvt_pk_bf16_f32 v80, v11, v13
  v_mov_b32 v81, v80
  v_cvt_pk_bf16_f32 v13, v12, v12
  v_lshlrev_b32 v13, 16, v13
  v_sub_f32 v13, v12, v13
  v_cvt_pk_bf16_f32 v82, v12, v13
  v_mov_b32 v83, v82
  s_mov_b32 exec_hi, 0
  buffer_store_dwordx2 v[80:81], v10, s[36:39], 0 offen
  buffer_store_dwordx2 v[82:83], v10, s[36:39], s54 offen
  s_endpgm
L_prep_x:
  s_mov_b32 s40, s16
  s_mov_b32 s41, s17
  s_mov_b32 s42, 2097152
  s_sub_u32 s54, s2, 464
  s_lshr_b32 s55, s54, 2
  s_and_b32 s56, s54, 3
  s_lshl_b32 s57, s55, 15
  s_lshl_b32 s58, s56, 8
  s_add_u32 s58, s58, s57
  v_lshlrev_b32 v5, 10, v3
  v_lshl_add_u32 v5, v4, 4, v5
  buffer_load_dwordx4 v[16:19], v5, s[40:43], s58 offen offset:0
  buffer_load_dwordx4 v[20:23], v5, s[40:43], s58 offen offset:32
  buffer_load_dwordx4 v[24:27], v5, s[40:43], s58 offen offset:64
  buffer_load_dwordx4 v[28:31], v5, s[40:43], s58 offen offset:96
  buffer_load_dwordx4 v[32:35], v5, s[40:43], s58 offen offset:128
  buffer_load_dwordx4 v[36:39], v5, s[40:43], s58 offen offset:160
  buffer_load_dwordx4 v[40:43], v5, s[40:43], s58 offen offset:192
  buffer_load_dwordx4 v[44:47], v5, s[40:43], s58 offen offset:224
  s_lshl_b32 s59, s56, 13
  s_add_u32 s59, s59, s57
  s_add_u32 s59, s59, 0x800000
  s_lshl_b32 s60, s55, 13
  s_lshl_b32 s61, s56, 11
  s_add_u32 s60, s60, s61
  s_add_u32 s60, s60, 0x1000000
  v_mov_b32 v64, 0
  v_mov_b32 v65, 0
  v_mov_b32 v66, 0
  v_mov_b32 v67, 0
  v_mov_b32 v68, 0
  v_mov_b32 v69, 0
  v_mov_b32 v70, 0
  v_mov_b32 v71, 0
  s_waitcnt vmcnt(7)
  v_permlane32_swap_b32 v16, v18
  v_permlane32_swap_b32 v17, v19
  s_nop 0
  s_nop 0
  buffer_store_dwordx4 v[16:19], v2, s[36:39], s59 offen offset:0
  v_dot2_f32_bf16 v64, v16, s53, v64
  v_dot2_f32_bf16 v65, v16, v16, v65
  v_dot2_f32_bf16 v64, v17, s53, v64
  v_dot2_f32_bf16 v65, v17, v17, v65
  v_dot2_f32_bf16 v64, v18, s53, v64
  v_dot2_f32_bf16 v65, v18, v18, v65
  v_dot2_f32_bf16 v64, v19, s53, v64
  v_dot2_f32_bf16 v65, v19, v19, v65
  s_waitcnt vmcnt(7)
  v_permlane32_swap_b32 v20, v22
  v_permlane32_swap_b32 v21, v23
  s_nop 0
  s_nop 0
  buffer_store_dwordx4 v[20:23], v2, s[36:39], s59 offen offset:1024
  v_dot2_f32_bf16 v64, v20, s53, v64
  v_dot2_f32_bf16 v65, v20, v20, v65
  v_dot2_f32_bf16 v64, v21, s53, v64
  v_dot2_f32_bf16 v65, v21, v21, v65
  v_dot2_f32_bf16 v64, v22, s53, v64
  v_dot2_f32_bf16 v65, v22, v22, v65
  v_dot2_f32_bf16 v64, v23, s53, v64
  v_dot2_f32_bf16 v65, v23, v23, v65
  s_waitcnt vmcnt(7)
  v_permlane32_swap_b32 v24, v26
  v_permlane32_swap_b32 v25, v27
  s_nop 0
  s_nop 0
  buffer_store_dwordx4 v[24:27], v2, s[36:39], s59 offen offset:2048
  v_dot2_f32_bf16 v66, v24, s53, v66
  v_dot2_f32_bf16 v67, v24, v24, v67
  v_dot2_f32_bf16 v66, v25, s53, v66
  v_dot2_f32_bf16 v67, v25, v25, v67
  v_dot2_f32_bf16 v66, v26, s53, v66
  v_dot2_f32_bf16 v67, v26, v26, v67
  v_dot2_f32_bf16 v66, v27, s53, v66
  v_dot2_f32_bf16 v67, v27, v27, v67
  s_waitcnt vmcnt(7)
  v_permlane32_swap_b32 v28, v30
  v_permlane32_swap_b32 v29, v31
  s_nop 0
  s_nop 0
  buffer_store_dwordx4 v[28:31], v2, s[36:39], s59 offen offset:3072
  v_dot2_f32_bf16 v66, v28, s53, v66
  v_dot2_f32_bf16 v67, v28, v28, v67
  v_dot2_f32_bf16 v66, v29, s53, v66
  v_dot2_f32_bf16 v67, v29, v29, v67
  v_dot2_f32_bf16 v66, v30, s53, v66
  v_dot2_f32_bf16 v67, v30, v30, v67
  v_dot2_f32_bf16 v66, v31, s53, v66
  v_dot2_f32_bf16 v67, v31, v31, v67
  s_waitcnt vmcnt(7)
  v_permlane32_swap_b32 v32, v34
  v_permlane32_swap_b32 v33, v35
  s_add_u32 s59, s59, 4096
  s_nop 0
  buffer_store_dwordx4 v[32:35], v2, s[36:39], s59 offen offset:0
  v_dot2_f32_bf16 v68, v32, s53, v68
  v_dot2_f32_bf16 v69, v32, v32, v69
  v_dot2_f32_bf16 v68, v33, s53, v68
  v_dot2_f32_bf16 v69, v33, v33, v69
  v_dot2_f32_bf16 v68, v34, s53, v68
  v_dot2_f32_bf16 v69, v34, v34, v69
  v_dot2_f32_bf16 v68, v35, s53, v68
  v_dot2_f32_bf16 v69, v35, v35, v69
  s_waitcnt vmcnt(7)
  v_permlane32_swap_b32 v36, v38
  v_permlane32_swap_b32 v37, v39
  s_nop 0
  s_nop 0
  buffer_store_dwordx4 v[36:39], v2, s[36:39], s59 offen offset:1024
  v_dot2_f32_bf16 v68, v36, s53, v68
  v_dot2_f32_bf16 v69, v36, v36, v69
  v_dot2_f32_bf16 v68, v37, s53, v68
  v_dot2_f32_bf16 v69, v37, v37, v69
  v_dot2_f32_bf16 v68, v38, s53, v68
  v_dot2_f32_bf16 v69, v38, v38, v69
  v_dot2_f32_bf16 v68, v39, s53, v68
  v_dot2_f32_bf16 v69, v39, v39, v69
  s_waitcnt vmcnt(7)
  v_permlane32_swap_b32 v40, v42
  v_permlane32_swap_b32 v41, v43
  s_nop 0
  s_nop 0
  buffer_store_dwordx4 v[40:43], v2, s[36:39], s59 offen offset:2048
  v_dot2_f32_bf16 v70, v40, s53, v70
  v_dot2_f32_bf16 v71, v40, v40, v71
  v_dot2_f32_bf16 v70, v41, s53, v70
  v_dot2_f32_bf16 v71, v41, v41, v71
  v_dot2_f32_bf16 v70, v42, s53, v70
  v_dot2_f32_bf16 v71, v42, v42, v71
  v_dot2_f32_bf16 v70, v43, s53, v70
  v_dot2_f32_bf16 v71, v43, v43, v71
  s_waitcnt vmcnt(7)
  v_permlane32_swap_b32 v44, v46
  v_permlane32_swap_b32 v45, v47
  s_nop 0
  s_nop 0
  buffer_store_dwordx4 v[44:47], v2, s[36:39], s59 offen offset:3072
  v_dot2_f32_bf16 v70, v44, s53, v70
  v_dot2_f32_bf16 v71, v44, v44, v71
  v_dot2_f32_bf16 v70, v45, s53, v70
  v_dot2_f32_bf16 v71, v45, v45, v71
  v_dot2_f32_bf16 v70, v46, s53, v70
  v_dot2_f32_bf16 v71, v46, v46, v71
  v_dot2_f32_bf16 v70, v47, s53, v70
  v_dot2_f32_bf16 v71, v47, v47, v71
  s_nop 3
  buffer_store_dwordx4 v[64:67], v2, s[36:39], s60 offen
  buffer_store_dwordx4 v[68:71], v2, s[36:39], s60 offen offset:1024
  s_endpgm
L_prep_zero:
  s_sub_u32 s4, s2, 720
  s_lshl_b32 s4, s4, 10
  s_add_u32 s4, s4, 0x5e0000
  v_mov_b32 v4, 0
  v_mov_b32 v5, 0
  v_mov_b32 v6, 0
  v_mov_b32 v7, 0
  buffer_store_dwordx4 v[4:7], v2, s[36:39], s4 offen
  s_endpgm
L_prep_touch:
  s_sub_u32 s4, s2, 848
  s_and_b32 s5, s4, 7
  s_lshr_b32 s6, s4, 3
  s_lshl_b32 s7, s5, 5
  s_add_u32 s7, s7, s6
  v_lshlrev_b32 v8, 7, v0
  s_mul_i32 s8, s7, 28672
  s_add_u32 s8, s8, 0x1c00000
  s_add_u32 s9, s8, 0
  buffer_load_dword v9, v8, s[36:39], s9 offen
  s_add_u32 s9, s8, 8192
  buffer_load_dword v9, v8, s[36:39], s9 offen
  s_add_u32 s9, s8, 16384
  buffer_load_dword v9, v8, s[36:39], s9 offen
  s_add_u32 s9, s8, 20480
  buffer_load_dword v9, v8, s[36:39], s9 offen
  s_lshl_b32 s8, s7, 13
  s_add_u32 s9, s8, 0x1a00000
  buffer_load_dword v9, v8, s[36:39], s9 offen
L_prep_end:
  s_endpgm
.section .rodata,"a"
.p2align 6
.amdhsa_kernel prep_kernel
  .amdhsa_next_free_vgpr 96
  .amdhsa_next_free_sgpr 102
  .amdhsa_accum_offset 96
  .amdhsa_group_segment_fixed_size 0
  .amdhsa_kernarg_size 80
  .amdhsa_user_sgpr_count 2
  .amdhsa_user_sgpr_kernarg_segment_ptr 1
  .amdhsa_system_sgpr_workgroup_id_x 1
.end_amdhsa_kernel
.text
.globl main_kernel
.p2align 8
.type main_kernel,@function
main_kernel:
  s_cmp_ge_u32 s2, 256
  s_cbranch_scc1 L_main_end
  s_load_dwordx4 s[64:67], s[0:1], 0
  s_load_dwordx2 s[68:69], s[0:1], 56
  s_load_dwordx4 s[72:75], s[0:1], 64
  s_getreg_b32 s52, hwreg(HW_REG_XCC_ID)
  v_lshrrev_b32 v1, 6, v0
  v_and_b32 v2, 63, v0
  v_and_b32 v3, 31, v0
  v_readfirstlane_b32 s3, v1
  v_bfe_u32 v4, v0, 5, 1
  v_lshlrev_b32 v5, 4, v2
  v_add_u32 v6, 0x10000, v5
  v_add_u32 v7, 0x20000, v5
  v_lshlrev_b32 v125, 2, v2
  v_mov_b32 v126, 1
  v_mov_b32 v127, 0
  s_and_b32 s4, s2, 7
  s_lshr_b32 s5, s2, 3
  s_and_b32 s52, s52, 15
  s_add_u32 s52, s52, 1
  s_mov_b32 s44, 0
  s_mov_b32 s55, 0
  s_mov_b32 s45, 0
  s_mov_b32 s46, 0x800000
  s_lshl_b32 s50, s4, 13
  s_add_u32 s50, s50, 0x5f0000
  s_add_u32 s47, s50, 2048
  s_mov_b32 s48, 0
  s_mov_b32 s49, 0x1000000
  s_mov_b32 s51, 0
  s_waitcnt lgkmcnt(0)
  s_mov_b32 s36, s74
  s_mov_b32 s37, s75
  s_mov_b32 s38, 0x10000000
  s_mov_b32 s39, 0x20000
  s_mov_b32 s40, s68
  s_mov_b32 s41, s69
  s_mov_b32 s42, 2097152
  s_mov_b32 s43, 0x20000
  s_mov_b32 s56, s66
  s_mov_b32 s57, s67
  s_mov_b32 s58, 1572864
  s_mov_b32 s59, 0x20000
  s_mov_b32 s60, s64
  s_mov_b32 s61, s65
  s_mov_b32 s62, 2097152
  s_mov_b32 s63, 0x20000
  s_mov_b32 s96, s72
  s_mov_b32 s97, s73
  s_mov_b32 s98, 256
  s_mov_b32 s99, 0x20000
  s_mov_b32 s54, 0
  s_cmp_lt_u32 s3, 4
  s_cbranch_scc1 L_main_kernel_1
  s_cmp_lg_u32 s3, 7
  s_cbranch_scc1 L_main_kernel_2
  s_lshl_b32 s13, s4, 9
  s_lshr_b32 s14, s5, 3
  s_lshl_b32 s14, s14, 7
  s_and_b32 s15, s5, 7
  s_lshl_b32 s15, s15, 2
  s_add_u32 s14, s14, s15
  s_add_u32 s14, s14, s13
  s_add_u32 s14, s14, 0x5e2000
  v_mov_b32 v9, s52
  s_mov_b64 exec, 1
  buffer_store_dword v9, v127, s[36:39], s14 offen sc1
  s_mov_b64 exec, -1
L_main_kernel_2:
  s_sub_u32 s9, s3, 4
  s_lshl_b32 s10, s9, 11
  s_lshr_b32 s15, s5, 1
  s_mul_i32 s15, s15, 98304
  s_add_u32 s15, s15, s10
  s_add_u32 s15, s15, 0x3400000
  s_add_u32 s15, s15, s55
  s_add_u32 m0, s10, 65536
  s_add_u32 s14, s15, 32768
  buffer_load_dwordx4 v5, s[36:39], s14 offen lds
  buffer_load_dwordx4 v5, s[36:39], s14 offen offset:1024 lds
  s_add_u32 m0, s10, 73728
  s_add_u32 s14, s15, 65536
  buffer_load_dwordx4 v5, s[36:39], s14 offen lds
  buffer_load_dwordx4 v5, s[36:39], s14 offen offset:1024 lds
  s_add_u32 m0, s10, 81920
  s_add_u32 s14, s15, 40960
  buffer_load_dwordx4 v5, s[36:39], s14 offen lds
  buffer_load_dwordx4 v5, s[36:39], s14 offen offset:1024 lds
  s_add_u32 m0, s10, 90112
  s_add_u32 s14, s15, 73728
  buffer_load_dwordx4 v5, s[36:39], s14 offen lds
  buffer_load_dwordx4 v5, s[36:39], s14 offen offset:1024 lds
  s_add_u32 m0, s10, 98304
  s_add_u32 s14, s15, 49152
  buffer_load_dwordx4 v5, s[36:39], s14 offen lds
  buffer_load_dwordx4 v5, s[36:39], s14 offen offset:1024 lds
  s_add_u32 m0, s10, 106496
  s_add_u32 s14, s15, 81920
  buffer_load_dwordx4 v5, s[36:39], s14 offen lds
  buffer_load_dwordx4 v5, s[36:39], s14 offen offset:1024 lds
  s_add_u32 m0, s10, 147456
  s_add_u32 s14, s15, 57344
  buffer_load_dwordx4 v5, s[36:39], s14 offen lds
  buffer_load_dwordx4 v5, s[36:39], s14 offen offset:1024 lds
  s_add_u32 m0, s10, 155648
  s_add_u32 s14, s15, 90112
  buffer_load_dwordx4 v5, s[36:39], s14 offen lds
  buffer_load_dwordx4 v5, s[36:39], s14 offen offset:1024 lds
  s_add_u32 m0, s10, 0
  s_add_u32 s14, s15, 0
  buffer_load_dwordx4 v5, s[36:39], s14 offen lds
  buffer_load_dwordx4 v5, s[36:39], s14 offen offset:1024 lds
  s_add_u32 m0, s10, 8192
  s_add_u32 s14, s15, 8192
  buffer_load_dwordx4 v5, s[36:39], s14 offen lds
  buffer_load_dwordx4 v5, s[36:39], s14 offen offset:1024 lds
  s_add_u32 m0, s10, 16384
  s_add_u32 s14, s15, 16384
  buffer_load_dwordx4 v5, s[36:39], s14 offen lds
  buffer_load_dwordx4 v5, s[36:39], s14 offen offset:1024 lds
  s_add_u32 m0, s10, 24576
  s_add_u32 s14, s15, 24576
  buffer_load_dwordx4 v5, s[36:39], s14 offen lds
  buffer_load_dwordx4 v5, s[36:39], s14 offen offset:1024 lds
L_main_kernel_1:
L_layer:
  s_and_b32 s6, s5, 1
  s_lshl_b32 s8, s4, 1
  s_add_u32 s21, s6, s8
  s_lshr_b32 s7, s5, 1
  s_and_b32 s9, s3, 3
  s_lshl_b32 s6, s21, 2
  s_add_u32 s6, s6, s9
  s_and_b32 s22, s6, 7
  s_lshl_b32 s13, s22, 6
  s_add_u32 s13, s13, s50
  s_cmp_ge_u32 s3, 4
  s_cbranch_scc1 RL_main_kernel_3
  s_lshl_b32 s14, s9, 11
  s_add_u32 s14, s14, 57344
  v_add_u32 v124, s14, v5
  s_mul_i32 s12, s7, 3072
  s_add_u32 s12, s12, 0x3580000
  s_add_u32 s12, s12, s55
  v_lshlrev_b32 v15, 3, v3
  v_lshl_add_u32 v15, v4, 9, v15
  buffer_load_dwordx2 v[96:97], v15, s[36:39], s12 offen offset:0
  buffer_load_dwordx2 v[98:99], v15, s[36:39], s12 offen offset:256
  buffer_load_dwordx2 v[100:101], v15, s[36:39], s12 offen offset:1024
  buffer_load_dwordx2 v[102:103], v15, s[36:39], s12 offen offset:1280
  buffer_load_dwordx2 v[104:105], v15, s[36:39], s12 offen offset:2048
  buffer_load_dwordx2 v[106:107], v15, s[36:39], s12 offen offset:2304
  s_lshl_b32 s8, s6, 15
  s_add_u32 s8, s8, s46
  s_lshl_b32 s15, s7, 17
  s_lshl_b32 s14, s6, 10
  s_add_u32 s15, s15, s14
  s_add_u32 s15, s15, s45
  v_and_b32 v119, 7, v2
  v_lshlrev_b32 v119, 7, v119
  v_bfe_u32 v14, v2, 3, 1
  v_lshl_add_u32 v119, v14, 16, v119
  v_bfe_u32 v14, v2, 4, 1
  v_lshl_add_u32 v119, v14, 21, v119
  s_cmp_eq_u32 s48, 0
  s_cbranch_scc1 L_main_kernel_5
  s_mov_b32 exec_lo, 0xffff
  s_mov_b32 exec_hi, 0
  s_add_u32 s31, s54, 1
  s_mov_b32 s53, 0
L_main_kernel_6:
  buffer_load_dword v14, v125, s[36:39], s13 offen sc1
  s_add_u32 s53, s53, 1
  s_waitcnt vmcnt(0)
  v_subrev_u32 v14, s31, v14
  v_cmp_lt_u32 vcc, 15, v14
  s_cbranch_vccz L_main_kernel_7
  s_cmp_lt_u32 s53, 400000
  s_cbranch_scc1 L_main_kernel_6
L_main_kernel_7:
  s_mov_b64 exec, -1
L_main_kernel_5:
  buffer_load_dwordx4 a[0:3], v5, s[36:39], s8 offen offset:0 sc1
  buffer_load_dwordx4 a[4:7], v5, s[36:39], s8 offen offset:1024 sc1
  buffer_load_dwordx4 a[8:11], v5, s[36:39], s8 offen offset:2048 sc1
  buffer_load_dwordx4 a[12:15], v5, s[36:39], s8 offen offset:3072 sc1
  s_add_u32 s8, s8, 4096
  buffer_load_dwordx4 a[16:19], v5, s[36:39], s8 offen offset:0 sc1
  buffer_load_dwordx4 a[20:23], v5, s[36:39], s8 offen offset:1024 sc1
  buffer_load_dwordx4 a[24:27], v5, s[36:39], s8 offen offset:2048 sc1
  buffer_load_dwordx4 a[28:31], v5, s[36:39], s8 offen offset:3072 sc1
  s_add_u32 s8, s8, 4096
  buffer_load_dwordx4 a[32:35], v5, s[36:39], s8 offen offset:0 sc1
  buffer_load_dwordx4 a[36:39], v5, s[36:39], s8 offen offset:1024 sc1
  buffer_load_dwordx4 a[40:43], v5, s[36:39], s8 offen offset:2048 sc1
  buffer_load_dwordx4 a[44:47], v5, s[36:39], s8 offen offset:3072 sc1
  s_add_u32 s8, s8, 4096
  buffer_load_dwordx4 a[48:51], v5, s[36:39], s8 offen offset:0 sc1
  buffer_load_dwordx4 a[52:55], v5, s[36:39], s8 offen offset:1024 sc1
  buffer_load_dwordx4 a[56:59], v5, s[36:39], s8 offen offset:2048 sc1
  buffer_load_dwordx4 a[60:63], v5, s[36:39], s8 offen offset:3072 sc1
  s_waitcnt lgkmcnt(0)
  s_barrier
  ds_read_b128 v[16:19], v6 offset:0
  ds_read_b128 v[20:23], v6 offset:8192
  ds_read_b128 v[24:27], v6 offset:1024
  ds_read_b128 v[28:31], v6 offset:9216
  s_waitcnt vmcnt(15)
  s_waitcnt lgkmcnt(3)
  v_mfma_f32_32x32x16_bf16 v[32:47], v[16:19], a[0:3], 0
  s_add_u32 s8, s8, 4096
  buffer_load_dwordx4 a[64:67], v5, s[36:39], s8 offen offset:0 sc1
  ds_read_b128 v[16:19], v6 offset:2048
  s_waitcnt lgkmcnt(3)
  v_mfma_f32_32x32x16_bf16 v[48:63], a[0:3], v[20:23], 0
  buffer_load_dwordx4 a[68:71], v5, s[36:39], s8 offen offset:1024 sc1
  ds_read_b128 v[20:23], v6 offset:10240
  s_waitcnt vmcnt(16)
  s_waitcnt lgkmcnt(3)
  v_mfma_f32_32x32x16_bf16 v[32:47], v[24:27], a[4:7], v[32:47]
  buffer_load_dwordx4 a[72:75], v5, s[36:39], s8 offen offset:2048 sc1
  ds_read_b128 v[24:27], v6 offset:3072
  s_waitcnt lgkmcnt(3)
  v_mfma_f32_32x32x16_bf16 v[48:63], a[4:7], v[28:31], v[48:63]
  buffer_load_dwordx4 a[76:79], v5, s[36:39], s8 offen offset:3072 sc1
  ds_read_b128 v[28:31], v6 offset:11264
  s_waitcnt vmcnt(17)
  s_waitcnt lgkmcnt(3)
  v_mfma_f32_32x32x16_bf16 v[32:47], v[16:19], a[8:11], v[32:47]
  s_add_u32 s8, s8, 4096
  buffer_load_dwordx4 a[80:83], v5, s[36:39], s8 offen offset:0 sc1
  ds_read_b128 v[16:19], v6 offset:4096
  s_waitcnt lgkmcnt(3)
  v_mfma_f32_32x32x16_bf16 v[48:63], a[8:11], v[20:23], v[48:63]
  buffer_load_dwordx4 a[84:87], v5, s[36:39], s8 offen offset:1024 sc1
  ds_read_b128 v[20:23], v6 offset:12288
  s_waitcnt vmcnt(18)
  s_waitcnt lgkmcnt(3)
  v_mfma_f32_32x32x16_bf16 v[32:47], v[24:27], a[12:15], v[32:47]
  buffer_load_dwordx4 a[88:91], v5, s[36:39], s8 offen offset:2048 sc1
  ds_read_b128 v[24:27], v6 offset:5120
  s_waitcnt lgkmcnt(3)
  v_mfma_f32_32x32x16_bf16 v[48:63], a[12:15], v[28:31], v[48:63]
  buffer_load_dwordx4 a[92:95], v5, s[36:39], s8 offen offset:3072 sc1
  ds_read_b128 v[28:31], v6 offset:13312
  s_waitcnt vmcnt(19)
  s_waitcnt lgkmcnt(3)
  v_mfma_f32_32x32x16_bf16 v[32:47], v[16:19], a[16:19], v[32:47]
  s_add_u32 s8, s8, 4096
  buffer_load_dwordx4 a[96:99], v5, s[36:39], s8 offen offset:0 sc1
  ds_read_b128 v[16:19], v6 offset:6144
  s_waitcnt lgkmcnt(3)
  v_mfma_f32_32x32x16_bf16 v[48:63], a[16:19], v[20:23], v[48:63]
  buffer_load_dwordx4 a[100:103], v5, s[36:39], s8 offen offset:1024 sc1
  ds_read_b128 v[20:23], v6 offset:14336
  s_waitcnt vmcnt(20)
  s_waitcnt lgkmcnt(3)
  v_mfma_f32_32x32x16_bf16 v[32:47], v[24:27], a[20:23], v[32:47]
  buffer_load_dwordx4 a[104:107], v5, s[36:39], s8 offen offset:2048 sc1
  ds_read_b128 v[24:27], v6 offset:7168
  s_waitcnt lgkmcnt(3)
  v_mfma_f32_32x32x16_bf16 v[48:63], a[20:23], v[28:31], v[48:63]
  buffer_load_dwordx4 a[108:111], v5, s[36:39], s8 offen offset:3072 sc1
  ds_read_b128 v[28:31], v6 offset:15360
  s_waitcnt vmcnt(21)
  s_waitcnt lgkmcnt(3)
  v_mfma_f32_32x32x16_bf16 v[32:47], v[16:19], a[24:27], v[32:47]
  s_add_u32 s8, s8, 4096
  buffer_load_dwordx4 a[112:115], v5, s[36:39], s8 offen offset:0 sc1
  s_waitcnt lgkmcnt(0)
  s_barrier
  ds_read_b128 v[16:19], v6 offset:16384
  v_mfma_f32_32x32x16_bf16 v[48:63], a[24:27], v[20:23], v[48:63]
  buffer_load_dwordx4 a[116:119], v5, s[36:39], s8 offen offset:1024 sc1
  ds_read_b128 v[20:23], v6 offset:24576
  s_waitcnt vmcnt(22)
  v_mfma_f32_32x32x16_bf16 v[32:47], v[24:27], a[28:31], v[32:47]
  buffer_load_dwordx4 a[120:123], v5, s[36:39], s8 offen offset:2048 sc1
  ds_read_b128 v[24:27], v6 offset:17408
  v_mfma_f32_32x32x16_bf16 v[48:63], a[28:31], v[28:31], v[48:63]
  buffer_load_dwordx4 a[124:127], v5, s[36:39], s8 offen offset:3072 sc1
  ds_read_b128 v[28:31], v6 offset:25600
  s_waitcnt vmcnt(23)
  s_waitcnt lgkmcnt(3)
  v_mfma_f32_32x32x16_bf16 v[32:47], v[16:19], a[32:35], v[32:47]
  ds_read_b128 v[16:19], v6 offset:18432
  s_waitcnt lgkmcnt(3)
  v_mfma_f32_32x32x16_bf16 v[48:63], a[32:35], v[20:23], v[48:63]
  ds_read_b128 v[20:23], v6 offset:26624
  s_waitcnt vmcnt(22)
  s_waitcnt lgkmcnt(3)
  v_mfma_f32_32x32x16_bf16 v[32:47], v[24:27], a[36:39], v[32:47]
  ds_read_b128 v[24:27], v6 offset:19456
  s_waitcnt lgkmcnt(3)
  v_mfma_f32_32x32x16_bf16 v[48:63], a[36:39], v[28:31], v[48:63]
  ds_read_b128 v[28:31], v6 offset:27648
  s_waitcnt vmcnt(21)
  s_waitcnt lgkmcnt(3)
  v_mfma_f32_32x32x16_bf16 v[32:47], v[16:19], a[40:43], v[32:47]
  ds_read_b128 v[16:19], v6 offset:20480
  s_waitcnt lgkmcnt(3)
  v_mfma_f32_32x32x16_bf16 v[48:63], a[40:43], v[20:23], v[48:63]
  ds_read_b128 v[20:23], v6 offset:28672
  s_waitcnt vmcnt(20)
  s_waitcnt lgkmcnt(3)
  v_mfma_f32_32x32x16_bf16 v[32:47], v[24:27], a[44:47], v[32:47]
  ds_read_b128 v[24:27], v6 offset:21504
  s_waitcnt lgkmcnt(3)
  v_mfma_f32_32x32x16_bf16 v[48:63], a[44:47], v[28:31], v[48:63]
  ds_read_b128 v[28:31], v6 offset:29696
  s_waitcnt vmcnt(19)
  s_waitcnt lgkmcnt(3)
  v_mfma_f32_32x32x16_bf16 v[32:47], v[16:19], a[48:51], v[32:47]
  ds_read_b128 v[16:19], v6 offset:22528
  s_waitcnt lgkmcnt(3)
  v_mfma_f32_32x32x16_bf16 v[48:63], a[48:51], v[20:23], v[48:63]
  ds_read_b128 v[20:23], v6 offset:30720
  s_waitcnt vmcnt(18)
  s_waitcnt lgkmcnt(3)
  v_mfma_f32_32x32x16_bf16 v[32:47], v[24:27], a[52:55], v[32:47]
  ds_read_b128 v[24:27], v6 offset:23552
  s_waitcnt lgkmcnt(3)
  v_mfma_f32_32x32x16_bf16 v[48:63], a[52:55], v[28:31], v[48:63]
  ds_read_b128 v[28:31], v6 offset:31744
  s_waitcnt vmcnt(17)
  s_waitcnt lgkmcnt(3)
  v_mfma_f32_32x32x16_bf16 v[32:47], v[16:19], a[56:59], v[32:47]
  s_waitcnt lgkmcnt(0)
  s_barrier
  ds_read_b128 v[16:19], v6 offset:32768
  v_mfma_f32_32x32x16_bf16 v[48:63], a[56:59], v[20:23], v[48:63]
  ds_read_b128 v[20:23], v6 offset:40960
  s_waitcnt vmcnt(16)
  v_mfma_f32_32x32x16_bf16 v[32:47], v[24:27], a[60:63], v[32:47]
  ds_read_b128 v[24:27], v6 offset:33792
  v_mfma_f32_32x32x16_bf16 v[48:63], a[60:63], v[28:31], v[48:63]
  ds_read_b128 v[28:31], v6 offset:41984
  s_waitcnt vmcnt(15)
  s_waitcnt lgkmcnt(3)
  v_mfma_f32_32x32x16_bf16 v[32:47], v[16:19], a[64:67], v[32:47]
  ds_read_b128 v[16:19], v6 offset:34816
  s_waitcnt lgkmcnt(3)
  v_mfma_f32_32x32x16_bf16 v[48:63], a[64:67], v[20:23], v[48:63]
  ds_read_b128 v[20:23], v6 offset:43008
  s_waitcnt vmcnt(14)
  s_waitcnt lgkmcnt(3)
  v_mfma_f32_32x32x16_bf16 v[32:47], v[24:27], a[68:71], v[32:47]
  ds_read_b128 v[24:27], v6 offset:35840
  s_waitcnt lgkmcnt(3)
  v_mfma_f32_32x32x16_bf16 v[48:63], a[68:71], v[28:31], v[48:63]
  ds_read_b128 v[28:31], v6 offset:44032
  s_waitcnt vmcnt(13)
  s_waitcnt lgkmcnt(3)
  v_mfma_f32_32x32x16_bf16 v[32:47], v[16:19], a[72:75], v[32:47]
  ds_read_b128 v[16:19], v6 offset:36864
  s_waitcnt lgkmcnt(3)
  v_mfma_f32_32x32x16_bf16 v[48:63], a[72:75], v[20:23], v[48:63]
  ds_read_b128 v[20:23], v6 offset:45056
  s_waitcnt vmcnt(12)
  s_waitcnt lgkmcnt(3)
  v_mfma_f32_32x32x16_bf16 v[32:47], v[24:27], a[76:79], v[32:47]
  ds_read_b128 v[24:27], v6 offset:37888
  s_waitcnt lgkmcnt(3)
  v_mfma_f32_32x32x16_bf16 v[48:63], a[76:79], v[28:31], v[48:63]
  ds_read_b128 v[28:31], v6 offset:46080
  s_waitcnt vmcnt(11)
  s_waitcnt lgkmcnt(3)
  v_mfma_f32_32x32x16_bf16 v[32:47], v[16:19], a[80:83], v[32:47]
  ds_read_b128 v[16:19], v6 offset:38912
  s_waitcnt lgkmcnt(3)
  v_mfma_f32_32x32x16_bf16 v[48:63], a[80:83], v[20:23], v[48:63]
  ds_read_b128 v[20:23], v6 offset:47104
  s_waitcnt vmcnt(10)
  s_waitcnt lgkmcnt(3)
  v_mfma_f32_32x32x16_bf16 v[32:47], v[24:27], a[84:87], v[32:47]
  ds_read_b128 v[24:27], v6 offset:39936
  s_waitcnt lgkmcnt(3)
  v_mfma_f32_32x32x16_bf16 v[48:63], a[84:87], v[28:31], v[48:63]
  ds_read_b128 v[28:31], v6 offset:48128
  s_waitcnt vmcnt(9)
  s_waitcnt lgkmcnt(3)
  v_mfma_f32_32x32x16_bf16 v[32:47], v[16:19], a[88:91], v[32:47]
  s_waitcnt lgkmcnt(0)
  s_barrier
  ds_read_b128 v[16:19], v7 offset:16384
  v_mfma_f32_32x32x16_bf16 v[48:63], a[88:91], v[20:23], v[48:63]
  ds_read_b128 v[20:23], v7 offset:24576
  s_waitcnt vmcnt(8)
  v_mfma_f32_32x32x16_bf16 v[32:47], v[24:27], a[92:95], v[32:47]
  ds_read_b128 v[24:27], v7 offset:17408
  v_mfma_f32_32x32x16_bf16 v[48:63], a[92:95], v[28:31], v[48:63]
  ds_read_b128 v[28:31], v7 offset:25600
  s_waitcnt vmcnt(7)
  s_waitcnt lgkmcnt(3)
  v_mfma_f32_32x32x16_bf16 v[32:47], v[16:19], a[96:99], v[32:47]
  ds_read_b128 v[16:19], v7 offset:18432
  s_waitcnt lgkmcnt(3)
  v_mfma_f32_32x32x16_bf16 v[48:63], a[96:99], v[20:23], v[48:63]
  ds_read_b128 v[20:23], v7 offset:26624
  s_waitcnt vmcnt(6)
  s_waitcnt lgkmcnt(3)
  v_mfma_f32_32x32x16_bf16 v[32:47], v[24:27], a[100:103], v[32:47]
  ds_read_b128 v[24:27], v7 offset:19456
  s_waitcnt lgkmcnt(3)
  v_mfma_f32_32x32x16_bf16 v[48:63], a[100:103], v[28:31], v[48:63]
  ds_read_b128 v[28:31], v7 offset:27648
  s_waitcnt vmcnt(5)
  s_waitcnt lgkmcnt(3)
  v_mfma_f32_32x32x16_bf16 v[32:47], v[16:19], a[104:107], v[32:47]
  ds_read_b128 v[16:19], v7 offset:20480
  s_waitcnt lgkmcnt(3)
  v_mfma_f32_32x32x16_bf16 v[48:63], a[104:107], v[20:23], v[48:63]
  ds_read_b128 v[20:23], v7 offset:28672
  s_waitcnt vmcnt(4)
  s_waitcnt lgkmcnt(3)
  v_mfma_f32_32x32x16_bf16 v[32:47], v[24:27], a[108:111], v[32:47]
  ds_read_b128 v[24:27], v7 offset:21504
  s_waitcnt lgkmcnt(3)
  v_mfma_f32_32x32x16_bf16 v[48:63], a[108:111], v[28:31], v[48:63]
  ds_read_b128 v[28:31], v7 offset:29696
  s_waitcnt vmcnt(3)
  s_waitcnt lgkmcnt(3)
  v_mfma_f32_32x32x16_bf16 v[32:47], v[16:19], a[112:115], v[32:47]
  ds_read_b128 v[16:19], v7 offset:22528
  s_waitcnt lgkmcnt(3)
  v_mfma_f32_32x32x16_bf16 v[48:63], a[112:115], v[20:23], v[48:63]
  ds_read_b128 v[20:23], v7 offset:30720
  s_waitcnt vmcnt(2)
  s_waitcnt lgkmcnt(3)
  v_mfma_f32_32x32x16_bf16 v[32:47], v[24:27], a[116:119], v[32:47]
  ds_read_b128 v[24:27], v7 offset:23552
  s_waitcnt lgkmcnt(3)
  v_mfma_f32_32x32x16_bf16 v[48:63], a[116:119], v[28:31], v[48:63]
  ds_read_b128 v[28:31], v7 offset:31744
  s_waitcnt vmcnt(1)
  s_waitcnt lgkmcnt(3)
  v_mfma_f32_32x32x16_bf16 v[32:47], v[16:19], a[120:123], v[32:47]
  s_waitcnt lgkmcnt(0)
  s_barrier
  ds_read_b128 v[8:11], v124
  ds_read_b64 v[12:13], v124 offset:1024
  ds_read_b32 v1, v124 offset:1032
  ds_read_b128 v[16:19], v5 offset:0
  v_mfma_f32_32x32x16_bf16 v[48:63], a[120:123], v[20:23], v[48:63]
  ds_read_b128 v[20:23], v5 offset:1024
  s_waitcnt vmcnt(0)
  v_mfma_f32_32x32x16_bf16 v[32:47], v[24:27], a[124:127], v[32:47]
  s_cmp_lg_u32 s48, 0
  s_cbranch_scc1 L_main_kernel_8
  s_lshl_b32 s13, s4, 9
  s_add_u32 s13, s13, 0x5e2000
  v_lshrrev_b32 v15, 3, v2
  v_lshlrev_b32 v15, 7, v15
  v_and_b32 v14, 7, v2
  v_lshl_add_u32 v15, v14, 2, v15
  s_mov_b32 exec_lo, 0xffffffff
  s_mov_b32 exec_hi, 0
  s_mov_b32 s53, 0
L_main_kernel_9:
  buffer_load_dword v14, v15, s[36:39], s13 offen sc1
  s_add_u32 s53, s53, 1
  s_waitcnt vmcnt(0)
  v_cmp_eq_u32 vcc, 0, v14
  s_cbranch_vccz L_main_kernel_10
  s_cmp_lt_u32 s53, 400000
  s_cbranch_scc1 L_main_kernel_9
L_main_kernel_10:
  v_cmp_ne_u32 vcc, s52, v14
  s_mov_b64 exec, -1
  s_cmp_eq_u64 vcc, 0
  s_cselect_b32 s44, 1, 0
L_main_kernel_8:
  ds_read_b128 v[24:27], v5 offset:2048
  v_mfma_f32_32x32x16_bf16 v[48:63], a[124:127], v[28:31], v[48:63]
  s_waitcnt lgkmcnt(3)
  v_mfma_f32_32x32x16_bf16 v[32:47], v[100:103], v[8:11], v[32:47]
  v_mfma_f32_32x32x16_bf16 v[48:63], v[8:11], v[104:107], v[48:63]
  ds_read_b128 v[28:31], v5 offset:3072
  s_waitcnt lgkmcnt(3)
  v_mfma_f32_32x32x16_bf16 v[64:79], v[16:19], a[0:3], 0
  ds_read_b128 v[16:19], v5 offset:4096
  s_waitcnt lgkmcnt(3)
  v_mfma_f32_32x32x16_bf16 v[64:79], v[20:23], a[4:7], v[64:79]
  ds_read_b128 v[20:23], v5 offset:5120
  s_waitcnt lgkmcnt(3)
  v_mfma_f32_32x32x16_bf16 v[64:79], v[24:27], a[8:11], v[64:79]
  ds_read_b128 v[24:27], v5 offset:6144
  s_waitcnt lgkmcnt(3)
  v_mfma_f32_32x32x16_bf16 v[64:79], v[28:31], a[12:15], v[64:79]
  s_lshl_b32 s14, s9, 11
  s_add_u32 s14, s14, 58376
  v_lshl_add_u32 v14, v4, 6, s14
  ds_read_b32 v80, v14 offset:0
  ds_read_b32 v81, v14 offset:16
  ds_read_b32 v82, v14 offset:32
  ds_read_b32 v83, v14 offset:48
  ds_read_b32 v84, v14 offset:128
  ds_read_b32 v85, v14 offset:144
  ds_read_b32 v86, v14 offset:160
  ds_read_b32 v87, v14 offset:176
  ds_read_b32 v88, v14 offset:256
  ds_read_b32 v89, v14 offset:272
  ds_read_b32 v90, v14 offset:288
  ds_read_b32 v91, v14 offset:304
  ds_read_b32 v92, v14 offset:384
  ds_read_b32 v93, v14 offset:400
  ds_read_b32 v94, v14 offset:416
  ds_read_b32 v95, v14 offset:432
  v_mul_f32 v32, v1, v32
  v_mul_f32 v33, v1, v33
  v_cvt_pk_bf16_f32 v32, v32, v33
  v_mul_f32 v34, v1, v34
  ds_read_b128 v[28:31], v5 offset:7168
  s_waitcnt lgkmcnt(15)
  v_mfma_f32_32x32x16_bf16 v[64:79], v[16:19], a[16:19], v[64:79]
  v_mul_f32 v35, v1, v35
  v_cvt_pk_bf16_f32 v33, v34, v35
  v_mul_f32 v36, v1, v36
  v_mul_f32 v37, v1, v37
  v_cvt_pk_bf16_f32 v34, v36, v37
  v_mul_f32 v38, v1, v38
  ds_read_b128 v[16:19], v5 offset:8192
  v_mfma_f32_32x32x16_bf16 v[64:79], v[20:23], a[20:23], v[64:79]
  v_mul_f32 v39, v1, v39
  v_cvt_pk_bf16_f32 v35, v38, v39
  v_mul_f32 v40, v1, v40
  v_mul_f32 v41, v1, v41
  v_cvt_pk_bf16_f32 v36, v40, v41
  v_mul_f32 v42, v1, v42
  ds_read_b128 v[20:23], v5 offset:9216
  v_mfma_f32_32x32x16_bf16 v[64:79], v[24:27], a[24:27], v[64:79]
  v_mul_f32 v43, v1, v43
  v_cvt_pk_bf16_f32 v37, v42, v43
  v_mul_f32 v44, v1, v44
  v_mul_f32 v45, v1, v45
  v_cvt_pk_bf16_f32 v38, v44, v45
  v_mul_f32 v46, v1, v46
  ds_read_b128 v[24:27], v5 offset:10240
  s_waitcnt lgkmcnt(3)
  v_mfma_f32_32x32x16_bf16 v[64:79], v[28:31], a[28:31], v[64:79]
  v_mul_f32 v47, v1, v47
  v_cvt_pk_bf16_f32 v39, v46, v47
  s_add_u32 s13, s15, 0x1600000
  s_add_u32 s14, s13, 65536
  buffer_store_dwordx4 v[32:35], v5, s[36:39], s13 offen sc1
  buffer_store_dwordx4 v[36:39], v5, s[36:39], s14 offen sc1
  ds_read_b128 v[28:31], v5 offset:11264
  s_waitcnt lgkmcnt(3)
  v_mfma_f32_32x32x16_bf16 v[64:79], v[16:19], a[32:35], v[64:79]
  v_mul_f32 v48, v80, v48
  v_mul_f32 v49, v81, v49
  v_cvt_pk_bf16_f32 v48, v48, v49
  v_mul_f32 v50, v82, v50
  v_mul_f32 v51, v83, v51
  v_cvt_pk_bf16_f32 v49, v50, v51
  ds_read_b128 v[16:19], v5 offset:12288
  s_waitcnt lgkmcnt(3)
  v_mfma_f32_32x32x16_bf16 v[64:79], v[20:23], a[36:39], v[64:79]
  v_mul_f32 v52, v84, v52
  v_mul_f32 v53, v85, v53
  v_cvt_pk_bf16_f32 v50, v52, v53
  v_mul_f32 v54, v86, v54
  v_mul_f32 v55, v87, v55
  v_cvt_pk_bf16_f32 v51, v54, v55
  ds_read_b128 v[20:23], v5 offset:13312
  s_waitcnt lgkmcnt(3)
  v_mfma_f32_32x32x16_bf16 v[64:79], v[24:27], a[40:43], v[64:79]
  v_mul_f32 v56, v88, v56
  v_mul_f32 v57, v89, v57
  v_cvt_pk_bf16_f32 v52, v56, v57
  v_mul_f32 v58, v90, v58
  v_mul_f32 v59, v91, v59
  v_cvt_pk_bf16_f32 v53, v58, v59
  ds_read_b128 v[24:27], v5 offset:14336
  s_waitcnt lgkmcnt(3)
  v_mfma_f32_32x32x16_bf16 v[64:79], v[28:31], a[44:47], v[64:79]
  v_mul_f32 v60, v92, v60
  v_mul_f32 v61, v93, v61
  v_cvt_pk_bf16_f32 v54, v60, v61
  v_mul_f32 v62, v94, v62
  v_mul_f32 v63, v95, v63
  v_cvt_pk_bf16_f32 v55, v62, v63
  ds_read_b128 v[28:31], v5 offset:15360
  s_waitcnt lgkmcnt(3)
  v_mfma_f32_32x32x16_bf16 v[64:79], v[16:19], a[48:51], v[64:79]
  v_lshrrev_b32 v14, 4, v3
  v_lshlrev_b32 v14, 16, v14
  v_and_b32 v15, 15, v3
  v_lshl_add_u32 v14, v15, 4, v14
  v_lshl_add_u32 v14, v4, 8, v14
  s_add_u32 s13, s15, 0x1800000
  buffer_store_dwordx4 v[48:51], v14, s[36:39], s13 offen sc1
  buffer_store_dwordx4 v[52:55], v14, s[36:39], s13 offen offset:512 sc1
  s_waitcnt lgkmcnt(0)
  s_barrier
  ds_read_b128 v[16:19], v5 offset:16384
  v_mfma_f32_32x32x16_bf16 v[64:79], v[20:23], a[52:55], v[64:79]
  s_lshl_b32 s13, s9, 10
  v_add_u32 v15, s13, v5
  ds_write_b128 v15, v[32:35] offset:40960
  v_add_u32 v15, 0x10000, v15
  ds_write_b128 v15, v[36:39] offset:57344
  v_lshrrev_b32 v15, 4, v3
  s_mov_b32 s14, 81920
  v_mul_lo_u32 v15, v15, s14
  v_and_b32 v14, 0xffff, v14
  v_add_u32 v15, v15, v14
  v_add_u32 v15, s13, v15
  ds_write_b128 v15, v[48:51] offset:53248
  ds_write_b128 v15, v[52:55] offset:53760
  ds_read_b128 v[20:23], v5 offset:17408
  v_mfma_f32_32x32x16_bf16 v[64:79], v[24:27], a[56:59], v[64:79]
  ds_read_b128 v[24:27], v5 offset:18432
  v_mfma_f32_32x32x16_bf16 v[64:79], v[28:31], a[60:63], v[64:79]
  ds_read_b128 v[28:31], v5 offset:19456
  s_waitcnt lgkmcnt(7)
  v_mfma_f32_32x32x16_bf16 v[64:79], v[16:19], a[64:67], v[64:79]
  ds_read_b128 v[16:19], v5 offset:20480
  s_waitcnt lgkmcnt(3)
  v_mfma_f32_32x32x16_bf16 v[64:79], v[20:23], a[68:71], v[64:79]
  ds_read_b128 v[20:23], v5 offset:21504
  s_waitcnt lgkmcnt(3)
  v_mfma_f32_32x32x16_bf16 v[64:79], v[24:27], a[72:75], v[64:79]
  ds_read_b128 v[24:27], v5 offset:22528
  s_waitcnt lgkmcnt(3)
  v_mfma_f32_32x32x16_bf16 v[64:79], v[28:31], a[76:79], v[64:79]
  ds_read_b128 v[28:31], v5 offset:23552
  s_waitcnt lgkmcnt(3)
  v_mfma_f32_32x32x16_bf16 v[64:79], v[16:19], a[80:83], v[64:79]
  ds_read_b128 v[16:19], v5 offset:24576
  s_waitcnt lgkmcnt(3)
  v_mfma_f32_32x32x16_bf16 v[64:79], v[20:23], a[84:87], v[64:79]
  ds_read_b128 v[20:23], v5 offset:25600
  s_waitcnt lgkmcnt(3)
  v_mfma_f32_32x32x16_bf16 v[64:79], v[24:27], a[88:91], v[64:79]
  ds_read_b128 v[24:27], v5 offset:26624
  s_waitcnt lgkmcnt(3)
  v_mfma_f32_32x32x16_bf16 v[64:79], v[28:31], a[92:95], v[64:79]
  ds_read_b128 v[28:31], v5 offset:27648
  s_waitcnt lgkmcnt(3)
  v_mfma_f32_32x32x16_bf16 v[64:79], v[16:19], a[96:99], v[64:79]
  ds_read_b128 v[16:19], v5 offset:28672
  s_waitcnt lgkmcnt(3)
  v_mfma_f32_32x32x16_bf16 v[64:79], v[20:23], a[100:103], v[64:79]
  ds_read_b128 v[20:23], v5 offset:29696
  s_waitcnt lgkmcnt(3)
  v_mfma_f32_32x32x16_bf16 v[64:79], v[24:27], a[104:107], v[64:79]
  ds_read_b128 v[24:27], v5 offset:30720
  s_waitcnt lgkmcnt(3)
  v_mfma_f32_32x32x16_bf16 v[64:79], v[28:31], a[108:111], v[64:79]
  ds_read_b128 v[28:31], v5 offset:31744
  s_waitcnt lgkmcnt(3)
  v_mfma_f32_32x32x16_bf16 v[64:79], v[16:19], a[112:115], v[64:79]
  s_lshl_b32 s13, s7, 5
  s_lshl_b32 s14, s22, 2
  s_add_u32 s13, s13, s14
  s_add_u32 s13, s13, s47
  s_add_u32 s14, s13, 512
  s_waitcnt vmcnt(0)
  s_mov_b64 exec, 1
  buffer_store_dword v126, v127, s[36:39], s14 offen sc1
  s_mov_b64 exec, -1
  s_waitcnt lgkmcnt(2)
  v_mfma_f32_32x32x16_bf16 v[64:79], v[20:23], a[116:119], v[64:79]
  s_waitcnt lgkmcnt(1)
  v_mfma_f32_32x32x16_bf16 v[64:79], v[24:27], a[120:123], v[64:79]
  s_waitcnt lgkmcnt(0)
  v_mfma_f32_32x32x16_bf16 v[64:79], v[28:31], a[124:127], v[64:79]
  v_mfma_f32_32x32x16_bf16 v[64:79], v[96:99], v[8:11], v[64:79]
  s_lshl_b32 s13, s9, 10
  v_add_u32 v15, s13, v7
  s_nop 9
  v_mul_f32 v64, v12, v64
  v_mul_f32 v65, v12, v65
  v_cvt_pk_bf16_f32 v64, v64, v65
  v_mul_f32 v66, v12, v66
  v_mul_f32 v67, v12, v67
  v_cvt_pk_bf16_f32 v65, v66, v67
  v_mul_f32 v68, v12, v68
  v_mul_f32 v69, v12, v69
  v_cvt_pk_bf16_f32 v66, v68, v69
  v_mul_f32 v70, v12, v70
  v_mul_f32 v71, v12, v71
  v_cvt_pk_bf16_f32 v67, v70, v71
  v_mul_f32 v72, v12, v72
  v_mul_f32 v73, v12, v73
  v_cvt_pk_bf16_f32 v68, v72, v73
  v_mul_f32 v74, v12, v74
  v_mul_f32 v75, v12, v75
  v_cvt_pk_bf16_f32 v69, v74, v75
  v_mul_f32 v76, v12, v76
  v_mul_f32 v77, v12, v77
  v_cvt_pk_bf16_f32 v70, v76, v77
  v_mul_f32 v78, v12, v78
  v_mul_f32 v79, v12, v79
  v_cvt_pk_bf16_f32 v71, v78, v79
  ds_write_b128 v15, v[68:71] offset:12288
  v_accvgpr_write_b32 a0, v64
  v_accvgpr_write_b32 a1, v65
  v_accvgpr_write_b32 a2, v66
  v_accvgpr_write_b32 a3, v67
  s_waitcnt lgkmcnt(0)
  s_branch RD_main_kernel_4
RL_main_kernel_3:
  s_lshl_b32 s10, s9, 11
  s_add_u32 s14, s10, 57344
  v_add_u32 v120, s14, v5
  s_lshl_b32 s11, s6, 13
  s_add_u32 s11, s11, s49
  s_cmp_eq_u32 s48, 0
  s_cbranch_scc1 L_main_kernel_11
  s_mov_b32 exec_lo, 0xffff
  s_mov_b32 exec_hi, 0
  s_add_u32 s31, s54, 1
  s_mov_b32 s53, 0
L_main_kernel_12:
  buffer_load_dword v10, v125, s[36:39], s13 offen sc1
  s_add_u32 s53, s53, 1
  s_waitcnt vmcnt(0)
  v_subrev_u32 v10, s31, v10
  v_cmp_lt_u32 vcc, 15, v10
  s_cbranch_vccz L_main_kernel_13
  s_cmp_lt_u32 s53, 400000
  s_cbranch_scc1 L_main_kernel_12
L_main_kernel_13:
  s_mov_b64 exec, -1
L_main_kernel_11:
  buffer_load_dwordx4 v[16:19], v5, s[36:39], s11 offen offset:0 sc1
  buffer_load_dwordx4 v[20:23], v5, s[36:39], s11 offen offset:1024 sc1
  buffer_load_dwordx4 v[24:27], v5, s[36:39], s11 offen offset:2048 sc1
  buffer_load_dwordx4 v[28:31], v5, s[36:39], s11 offen offset:3072 sc1
  s_add_u32 s11, s11, 4096
  buffer_load_dwordx4 v[32:35], v5, s[36:39], s11 offen offset:0 sc1
  buffer_load_dwordx4 v[36:39], v5, s[36:39], s11 offen offset:1024 sc1
  buffer_load_dwordx4 v[40:43], v5, s[36:39], s11 offen offset:2048 sc1
  buffer_load_dwordx4 v[44:47], v5, s[36:39], s11 offen offset:3072 sc1
  s_waitcnt vmcnt(28)
  s_barrier
  s_waitcnt vmcnt(24)
  s_barrier
  s_waitcnt vmcnt(0)
  v_add_f32 v16, v16, v18
  v_add_f32 v17, v17, v19
  v_add_f32 v20, v20, v22
  v_add_f32 v21, v21, v23
  v_add_f32 v24, v24, v26
  v_add_f32 v25, v25, v27
  v_add_f32 v28, v28, v30
  v_add_f32 v29, v29, v31
  v_add_f32 v32, v32, v34
  v_add_f32 v33, v33, v35
  v_add_f32 v36, v36, v38
  v_add_f32 v37, v37, v39
  v_add_f32 v40, v40, v42
  v_add_f32 v41, v41, v43
  v_add_f32 v44, v44, v46
  v_add_f32 v45, v45, v47
  v_add_f32 v16, v16, v20
  v_add_f32 v17, v17, v21
  v_add_f32 v24, v24, v28
  v_add_f32 v25, v25, v29
  v_add_f32 v32, v32, v36
  v_add_f32 v33, v33, v37
  v_add_f32 v40, v40, v44
  v_add_f32 v41, v41, v45
  v_add_f32 v16, v16, v24
  v_add_f32 v17, v17, v25
  v_add_f32 v32, v32, v40
  v_add_f32 v33, v33, v41
  v_add_f32 v16, v16, v32
  v_add_f32 v17, v17, v33
  v_mov_b32 v10, v16
  v_mov_b32 v11, v17
  s_nop 1
  v_permlane32_swap_b32 v16, v10
  v_permlane32_swap_b32 v17, v11
  s_nop 1
  v_add_f32 v16, v16, v10
  v_add_f32 v17, v17, v11
  v_mul_f32 v8, 0xbb000000, v16
  v_mul_f32 v10, 0x3b000000, v17
  v_fma_f32 v10, -v8, v8, v10
  v_max_f32 v10, 0, v10
  v_add_f32 v13, 0x3727c5ac, v10
  v_rsq_f32 v14, v13
  v_cvt_pk_bf16_f32 v116, v8, v8
  v_lshlrev_b32 v10, 16, v116
  v_sub_f32 v10, v8, v10
  v_cvt_pk_bf16_f32 v117, v10, v10
  v_mov_b32 v118, v116
  v_mov_b32 v119, v117
  v_mul_f32 v12, 0x3eb8aa3b, v14
  ds_write_b128 v120, v[116:119]
  ds_write_b96 v120, v[12:14] offset:1024
  s_waitcnt lgkmcnt(0)
  s_barrier
  s_barrier
  s_cmp_lg_u32 s48, 0
  s_cbranch_scc1 L_main_kernel_14
  s_lshl_b32 s13, s4, 9
  s_add_u32 s13, s13, 0x5e2000
  v_lshrrev_b32 v11, 3, v2
  v_lshlrev_b32 v11, 7, v11
  v_and_b32 v10, 7, v2
  v_lshl_add_u32 v11, v10, 2, v11
  s_mov_b32 exec_lo, 0xffffffff
  s_mov_b32 exec_hi, 0
  s_mov_b32 s53, 0
L_main_kernel_15:
  buffer_load_dword v10, v11, s[36:39], s13 offen sc1
  s_add_u32 s53, s53, 1
  s_waitcnt vmcnt(0)
  v_cmp_eq_u32 vcc, 0, v10
  s_cbranch_vccz L_main_kernel_16
  s_cmp_lt_u32 s53, 400000
  s_cbranch_scc1 L_main_kernel_15
L_main_kernel_16:
  v_cmp_ne_u32 vcc, s52, v10
  s_mov_b64 exec, -1
  s_cmp_eq_u64 vcc, 0
  s_cselect_b32 s44, 1, 0
L_main_kernel_14:
  s_barrier
  s_barrier
  s_lshr_b32 s8, s9, 1
  s_and_b32 s17, s9, 1
  s_add_u32 s11, s21, s8
  s_sub_i32 s11, s11, 2
  s_mul_i32 s12, s17, 81920
  s_lshl_b32 s13, s8, 12
  s_add_u32 s12, s12, s13
  s_add_u32 s12, s12, 32768
  s_cmp_lt_i32 s11, 0
  s_cbranch_scc1 L_main_kernel_17
  s_mov_b32 s15, 0x400000
  s_mov_b32 s16, 512
  s_lshr_b32 s13, s11, 1
  s_cmp_eq_u32 s13, s4
  s_cbranch_scc1 L_main_kernel_19
  s_mov_b32 s15, 0x400000
  s_mov_b32 s16, -7680
L_main_kernel_19:
  s_lshl_b32 s13, s7, 5
  s_and_b32 s14, s11, 1
  s_lshl_b32 s14, s14, 4
  s_add_u32 s13, s13, s14
  s_add_u32 s13, s13, s47
  s_add_u32 s13, s13, s16
  s_lshl_b32 s18, s7, 1
  s_add_u32 s17, s18, s17
  s_lshl_b32 s17, s17, 6
  s_lshl_b32 s14, s11, 2
  s_add_u32 s17, s17, s14
  s_lshl_b32 s17, s17, 10
  s_add_u32 s17, s17, s45
  s_add_u32 s17, s17, s15
  s_add_u32 s18, s17, 0x1400000
  s_add_u32 s17, s17, 0x1200000
  s_mov_b32 exec_lo, 0xf
  s_mov_b32 exec_hi, 0
  s_add_u32 s31, s54, 1
  s_mov_b32 s53, 0
L_main_kernel_20:
  buffer_load_dword v10, v125, s[36:39], s13 offen sc1
  s_add_u32 s53, s53, 1
  s_waitcnt vmcnt(0)
  v_subrev_u32 v10, s31, v10
  v_cmp_lt_u32 vcc, 15, v10
  s_cbranch_vccz L_main_kernel_21
  s_cmp_lt_u32 s53, 400000
  s_cbranch_scc1 L_main_kernel_20
L_main_kernel_21:
  s_mov_b64 exec, -1
  s_mov_b32 m0, s12
  s_nop 0
  buffer_load_dwordx4 v5, s[36:39], s17 offen offset:0 sc1 lds
  buffer_load_dwordx4 v5, s[36:39], s17 offen offset:1024 sc1 lds
  buffer_load_dwordx4 v5, s[36:39], s17 offen offset:2048 sc1 lds
  buffer_load_dwordx4 v5, s[36:39], s17 offen offset:3072 sc1 lds
  s_add_u32 m0, s12, 12288
  s_nop 0
  buffer_load_dwordx4 v5, s[36:39], s18 offen offset:0 sc1 lds
  buffer_load_dwordx4 v5, s[36:39], s18 offen offset:1024 sc1 lds
  buffer_load_dwordx4 v5, s[36:39], s18 offen offset:2048 sc1 lds
  buffer_load_dwordx4 v5, s[36:39], s18 offen offset:3072 sc1 lds
  s_branch L_main_kernel_18
L_main_kernel_17:
  s_mov_b32 m0, s12
  s_nop 0
  buffer_load_dwordx4 v5, s[56:59], 0 offen offset:0 lds
  buffer_load_dwordx4 v5, s[56:59], 0 offen offset:1024 lds
  buffer_load_dwordx4 v5, s[56:59], 0 offen offset:2048 lds
  buffer_load_dwordx4 v5, s[56:59], 0 offen offset:3072 lds
  s_add_u32 m0, s12, 12288
  s_nop 0
  buffer_load_dwordx4 v5, s[56:59], 0 offen offset:0 lds
  buffer_load_dwordx4 v5, s[56:59], 0 offen offset:1024 lds
  buffer_load_dwordx4 v5, s[56:59], 0 offen offset:2048 lds
  buffer_load_dwordx4 v5, s[56:59], 0 offen offset:3072 lds
L_main_kernel_18:
RD_main_kernel_4:
  s_and_b32 s6, s5, 1
  s_lshl_b32 s8, s4, 1
  s_add_u32 s6, s6, s8
  s_lshl_b32 s6, s6, 2
  s_and_b32 s8, s3, 3
  s_add_u32 s6, s6, s8
  s_lshr_b32 s9, s3, 2
  s_and_b32 s7, s5, 0xfe
  s_add_u32 s7, s7, s9
  v_lshlrev_b32 v120, 2, v4
  v_sub_u32 v120, v3, v120
  s_mov_b32 s13, 0xf149f2ca
  v_mov_b32 v121, s13
  v_cmp_gt_i32 s[64:65], 0, v120
  v_cmp_gt_i32 s[66:67], 1, v120
  v_cmp_gt_i32 s[68:69], 2, v120
  v_cmp_gt_i32 s[70:71], 3, v120
  v_cmp_gt_i32 s[72:73], 8, v120
  v_cmp_gt_i32 s[74:75], 9, v120
  v_cmp_gt_i32 s[76:77], 10, v120
  v_cmp_gt_i32 s[78:79], 11, v120
  v_cmp_gt_i32 s[80:81], 16, v120
  v_cmp_gt_i32 s[82:83], 17, v120
  v_cmp_gt_i32 s[84:85], 18, v120
  v_cmp_gt_i32 s[86:87], 19, v120
  v_cmp_gt_i32 s[88:89], 24, v120
  v_cmp_gt_i32 s[90:91], 25, v120
  v_cmp_gt_i32 s[92:93], 26, v120
  v_cmp_gt_i32 s[94:95], 27, v120
  v_cndmask_b32 v40, v121, 0, s[64:65]
  v_cndmask_b32 v56, 0, v121, s[64:65]
  v_mov_b32 v88, v121
  v_cndmask_b32 v41, v121, 0, s[66:67]
  v_cndmask_b32 v57, 0, v121, s[66:67]
  v_mov_b32 v89, v121
  v_cndmask_b32 v42, v121, 0, s[68:69]
  v_cndmask_b32 v58, 0, v121, s[68:69]
  v_mov_b32 v90, v121
  v_cndmask_b32 v43, v121, 0, s[70:71]
  v_cndmask_b32 v59, 0, v121, s[70:71]
  v_mov_b32 v91, v121
  v_cndmask_b32 v44, v121, 0, s[72:73]
  v_cndmask_b32 v60, 0, v121, s[72:73]
  v_mov_b32 v92, v121
  v_cndmask_b32 v45, v121, 0, s[74:75]
  v_cndmask_b32 v61, 0, v121, s[74:75]
  v_mov_b32 v93, v121
  v_cndmask_b32 v46, v121, 0, s[76:77]
  v_cndmask_b32 v62, 0, v121, s[76:77]
  v_mov_b32 v94, v121
  v_cndmask_b32 v47, v121, 0, s[78:79]
  v_cndmask_b32 v63, 0, v121, s[78:79]
  v_mov_b32 v95, v121
  v_cndmask_b32 v48, v121, 0, s[80:81]
  v_cndmask_b32 v64, 0, v121, s[80:81]
  v_mov_b32 v96, v121
  v_cndmask_b32 v49, v121, 0, s[82:83]
  v_cndmask_b32 v65, 0, v121, s[82:83]
  v_mov_b32 v97, v121
  v_cndmask_b32 v50, v121, 0, s[84:85]
  v_cndmask_b32 v66, 0, v121, s[84:85]
  v_mov_b32 v98, v121
  v_cndmask_b32 v51, v121, 0, s[86:87]
  v_cndmask_b32 v67, 0, v121, s[86:87]
  v_mov_b32 v99, v121
  v_cndmask_b32 v52, v121, 0, s[88:89]
  v_cndmask_b32 v68, 0, v121, s[88:89]
  v_mov_b32 v100, v121
  v_cndmask_b32 v53, v121, 0, s[90:91]
  v_cndmask_b32 v69, 0, v121, s[90:91]
  v_mov_b32 v101, v121
  v_cndmask_b32 v54, v121, 0, s[92:93]
  v_cndmask_b32 v70, 0, v121, s[92:93]
  v_mov_b32 v102, v121
  v_cndmask_b32 v55, v121, 0, s[94:95]
  v_cndmask_b32 v71, 0, v121, s[94:95]
  v_mov_b32 v103, v121
  v_cmp_eq_u32 s[64:65], 16, v3
  v_cmp_eq_u32 s[66:67], 20, v3
  s_mov_b32 s14, 0x3f803f80
  v_mov_b32 v121, s14
  s_or_b64 s[64:65], s[64:65], s[66:67]
  s_nop 0
  v_cndmask_b32 v121, 0, v121, s[64:65]
  v_accvgpr_write_b32 a40, v121
  v_accvgpr_write_b32 a41, v121
  v_accvgpr_write_b32 a42, v121
  v_accvgpr_write_b32 a43, v121
  v_accvgpr_write_b32 a44, v121
  v_accvgpr_write_b32 a45, v121
  v_accvgpr_write_b32 a46, v121
  v_accvgpr_write_b32 a47, v121
  v_accvgpr_write_b32 a48, v121
  v_accvgpr_write_b32 a49, v121
  v_accvgpr_write_b32 a50, v121
  v_accvgpr_write_b32 a51, v121
  v_accvgpr_write_b32 a52, v121
  v_accvgpr_write_b32 a53, v121
  v_accvgpr_write_b32 a54, v121
  v_accvgpr_write_b32 a55, v121
  s_mov_b32 s64, 0x0000ffff
  s_mov_b32 s65, 0x0000ffff
  s_mul_i32 s13, s9, 81920
  s_lshl_b32 s14, s8, 10
  s_add_u32 s13, s13, s14
  s_add_u32 s13, s13, 32768
  v_add_u32 v122, s13, v5
  v_and_b32 v123, 15, v3
  v_lshlrev_b32 v123, 4, v123
  v_lshl_add_u32 v123, v4, 8, v123
  v_add_u32 v123, s13, v123
  v_add_u32 v120, s14, v7
  s_waitcnt vmcnt(0)
  s_lshl_b32 s13, s6, 5
  s_add_u32 s13, s13, s7
  s_lshl_b32 s13, s13, 10
  s_add_u32 s13, s13, 0x1a00000
  v_lshlrev_b32 v121, 7, v2
  s_mov_b32 exec_lo, 0xff
  s_mov_b32 exec_hi, 0
  buffer_load_dword v124, v121, s[36:39], s13 offen sc1
  s_mov_b64 exec, -1
  s_barrier
  s_cmp_lt_u32 s3, 4
  s_cbranch_scc1 L_main_kernel_22
  ds_read_b128 a[0:3], v120 offset:12288
L_main_kernel_22:
  ds_read_b128 a[4:7], v122 offset:0
  ds_read_b128 a[8:11], v122 offset:1024
  ds_read_b128 a[12:15], v122 offset:2048
  ds_read_b128 a[16:19], v122 offset:3072
  ds_read_b128 a[20:23], v122 offset:4096
  ds_read_b128 a[24:27], v122 offset:5120
  ds_read_b128 a[28:31], v122 offset:6144
  ds_read_b128 a[32:35], v122 offset:7168
  ds_read_b128 a[36:39], v122 offset:8192
  s_cmp_lg_u32 s3, 0
  s_cbranch_scc1 L_main_kernel_23
L_main_kernel_23:
  s_lshl_b32 s13, s3, 10
  s_lshr_b32 s19, s5, 1
  s_mul_i32 s19, s19, 229376
  s_add_u32 s19, s19, s13
  s_add_u32 s19, s19, 0x80000
  s_waitcnt lgkmcnt(8)
  s_cmp_lt_u32 s6, 8
  s_cbranch_scc1 L_main_kernel_24
  v_mfma_f32_32x32x16_bf16 v[8:23], a[4:7], a[0:3], v[40:55]
  s_branch L_main_kernel_25
L_main_kernel_24:
  v_mfma_f32_32x32x16_bf16 v[8:23], a[4:7], a[0:3], v[88:103]
L_main_kernel_25:
  s_waitcnt lgkmcnt(7)
  s_cmp_lt_u32 s6, 7
  s_cbranch_scc1 L_main_kernel_26
  v_mfma_f32_32x32x16_bf16 v[24:39], a[8:11], a[0:3], 0
  s_branch L_main_kernel_27
L_main_kernel_26:
  v_mfma_f32_32x32x16_bf16 v[24:39], a[8:11], a[0:3], v[88:103]
L_main_kernel_27:
  s_nop 7
  v_max_f32 v120, v8, v9
  v_max3_f32 v120, v120, v10, v11
  v_max3_f32 v120, v120, v12, v13
  v_max3_f32 v120, v120, v14, v15
  v_max3_f32 v120, v120, v16, v17
  v_max3_f32 v120, v120, v18, v19
  v_max3_f32 v120, v120, v20, v21
  v_max3_f32 v120, v120, v22, v23
  s_waitcnt lgkmcnt(6)
  s_cmp_lt_u32 s6, 6
  s_cbranch_scc1 L_main_kernel_28
  v_mfma_f32_32x32x16_bf16 v[8:23], a[12:15], a[0:3], 0
  s_branch L_main_kernel_29
L_main_kernel_28:
  v_mfma_f32_32x32x16_bf16 v[8:23], a[12:15], a[0:3], v[88:103]
L_main_kernel_29:
  v_max3_f32 v120, v120, v24, v25
  v_max3_f32 v120, v120, v26, v27
  v_max3_f32 v120, v120, v28, v29
  v_max3_f32 v120, v120, v30, v31
  v_max3_f32 v120, v120, v32, v33
  v_max3_f32 v120, v120, v34, v35
  v_max3_f32 v120, v120, v36, v37
  v_max3_f32 v120, v120, v38, v39
  s_add_u32 m0, s13, 65536
  s_add_u32 s14, s19, 0
  buffer_load_dwordx4 v5, s[36:39], s14 offen lds
  s_waitcnt lgkmcnt(5)
  s_cmp_lt_u32 s6, 5
  s_cbranch_scc1 L_main_kernel_30
  v_mfma_f32_32x32x16_bf16 v[24:39], a[16:19], a[0:3], 0
  s_branch L_main_kernel_31
L_main_kernel_30:
  v_mfma_f32_32x32x16_bf16 v[24:39], a[16:19], a[0:3], v[88:103]
L_main_kernel_31:
  v_max3_f32 v120, v120, v8, v9
  v_max3_f32 v120, v120, v10, v11
  v_max3_f32 v120, v120, v12, v13
  v_max3_f32 v120, v120, v14, v15
  v_max3_f32 v120, v120, v16, v17
  v_max3_f32 v120, v120, v18, v19
  v_max3_f32 v120, v120, v20, v21
  v_max3_f32 v120, v120, v22, v23
  s_waitcnt lgkmcnt(4)
  s_cmp_lt_u32 s6, 4
  s_cbranch_scc1 L_main_kernel_32
  v_mfma_f32_32x32x16_bf16 v[8:23], a[20:23], a[0:3], 0
  s_branch L_main_kernel_33
L_main_kernel_32:
  v_mfma_f32_32x32x16_bf16 v[8:23], a[20:23], a[0:3], v[88:103]
L_main_kernel_33:
  v_max3_f32 v120, v120, v24, v25
  v_max3_f32 v120, v120, v26, v27
  v_max3_f32 v120, v120, v28, v29
  v_max3_f32 v120, v120, v30, v31
  v_max3_f32 v120, v120, v32, v33
  v_max3_f32 v120, v120, v34, v35
  v_max3_f32 v120, v120, v36, v37
  v_max3_f32 v120, v120, v38, v39
  s_add_u32 m0, s13, 73728
  s_add_u32 s14, s19, 32768
  buffer_load_dwordx4 v5, s[36:39], s14 offen lds
  s_waitcnt lgkmcnt(3)
  s_cmp_lt_u32 s6, 3
  s_cbranch_scc1 L_main_kernel_34
  v_mfma_f32_32x32x16_bf16 v[24:39], a[24:27], a[0:3], 0
  s_branch L_main_kernel_35
L_main_kernel_34:
  v_mfma_f32_32x32x16_bf16 v[24:39], a[24:27], a[0:3], v[88:103]
L_main_kernel_35:
  v_max3_f32 v120, v120, v8, v9
  v_max3_f32 v120, v120, v10, v11
  v_max3_f32 v120, v120, v12, v13
  v_max3_f32 v120, v120, v14, v15
  v_max3_f32 v120, v120, v16, v17
  v_max3_f32 v120, v120, v18, v19
  v_max3_f32 v120, v120, v20, v21
  v_max3_f32 v120, v120, v22, v23
  s_waitcnt lgkmcnt(2)
  s_cmp_lt_u32 s6, 2
  s_cbranch_scc1 L_main_kernel_36
  v_mfma_f32_32x32x16_bf16 v[8:23], a[28:31], a[0:3], 0
  s_branch L_main_kernel_37
L_main_kernel_36:
  v_mfma_f32_32x32x16_bf16 v[8:23], a[28:31], a[0:3], v[88:103]
L_main_kernel_37:
  v_max3_f32 v120, v120, v24, v25
  v_max3_f32 v120, v120, v26, v27
  v_max3_f32 v120, v120, v28, v29
  v_max3_f32 v120, v120, v30, v31
  v_max3_f32 v120, v120, v32, v33
  v_max3_f32 v120, v120, v34, v35
  v_max3_f32 v120, v120, v36, v37
  v_max3_f32 v120, v120, v38, v39
  s_add_u32 m0, s13, 81920
  s_add_u32 s14, s19, 8192
  buffer_load_dwordx4 v5, s[36:39], s14 offen lds
  s_waitcnt lgkmcnt(1)
  s_cmp_lt_u32 s6, 1
  s_cbranch_scc1 L_main_kernel_38
  v_mfma_f32_32x32x16_bf16 v[24:39], a[32:35], a[0:3], 0
  s_branch L_main_kernel_39
L_main_kernel_38:
  v_mfma_f32_32x32x16_bf16 v[24:39], a[32:35], a[0:3], v[88:103]
L_main_kernel_39:
  v_max3_f32 v120, v120, v8, v9
  v_max3_f32 v120, v120, v10, v11
  v_max3_f32 v120, v120, v12, v13
  v_max3_f32 v120, v120, v14, v15
  v_max3_f32 v120, v120, v16, v17
  v_max3_f32 v120, v120, v18, v19
  v_max3_f32 v120, v120, v20, v21
  v_max3_f32 v120, v120, v22, v23
  s_waitcnt lgkmcnt(0)
  v_mfma_f32_32x32x16_bf16 v[8:23], a[36:39], a[0:3], v[56:71]
  v_max3_f32 v120, v120, v24, v25
  v_max3_f32 v120, v120, v26, v27
  v_max3_f32 v120, v120, v28, v29
  v_max3_f32 v120, v120, v30, v31
  v_max3_f32 v120, v120, v32, v33
  v_max3_f32 v120, v120, v34, v35
  v_max3_f32 v120, v120, v36, v37
  v_max3_f32 v120, v120, v38, v39
  s_add_u32 m0, s13, 90112
  s_add_u32 s14, s19, 40960
  buffer_load_dwordx4 v5, s[36:39], s14 offen lds
  s_nop 3
  v_max3_f32 v120, v120, v8, v9
  v_max3_f32 v120, v120, v10, v11
  v_max3_f32 v120, v120, v12, v13
  v_max3_f32 v120, v120, v14, v15
  v_max3_f32 v120, v120, v16, v17
  v_max3_f32 v120, v120, v18, v19
  v_max3_f32 v120, v120, v20, v21
  v_max3_f32 v120, v120, v22, v23
  s_mov_b64 exec, s[64:65]
  ds_read_b128 a[40:43], v123 offset:12288
  ds_read_b128 a[44:47], v123 offset:12800
  s_mov_b64 exec, -1
  v_mov_b32 v121, v120
  s_nop 1
  v_permlane32_swap_b32 v120, v121
  s_nop 1
  v_max_f32 v120, v120, v121
  v_sub_f32 v40, v40, v120
  v_sub_f32 v41, v41, v120
  v_sub_f32 v42, v42, v120
  v_sub_f32 v43, v43, v120
  v_sub_f32 v44, v44, v120
  v_sub_f32 v45, v45, v120
  v_sub_f32 v46, v46, v120
  v_sub_f32 v47, v47, v120
  v_sub_f32 v48, v48, v120
  v_sub_f32 v49, v49, v120
  v_sub_f32 v50, v50, v120
  v_sub_f32 v51, v51, v120
  v_sub_f32 v52, v52, v120
  v_sub_f32 v53, v53, v120
  v_sub_f32 v54, v54, v120
  v_sub_f32 v55, v55, v120
  v_sub_f32 v72, 0, v120
  v_sub_f32 v73, 0, v120
  v_sub_f32 v74, 0, v120
  v_sub_f32 v75, 0, v120
  v_sub_f32 v76, 0, v120
  v_sub_f32 v77, 0, v120
  v_sub_f32 v78, 0, v120
  v_sub_f32 v79, 0, v120
  v_sub_f32 v80, 0, v120
  v_sub_f32 v81, 0, v120
  v_sub_f32 v82, 0, v120
  v_sub_f32 v83, 0, v120
  v_sub_f32 v84, 0, v120
  v_sub_f32 v85, 0, v120
  v_sub_f32 v86, 0, v120
  v_sub_f32 v87, 0, v120
  s_cmp_lt_u32 s6, 8
  s_cbranch_scc1 L_main_kernel_40
  v_mfma_f32_32x32x16_bf16 v[8:23], a[4:7], a[0:3], v[40:55]
  s_branch L_main_kernel_41
L_main_kernel_40:
  v_mfma_f32_32x32x16_bf16 v[8:23], a[4:7], a[0:3], v[88:103]
L_main_kernel_41:
  v_sub_f32 v56, v56, v120
  v_sub_f32 v57, v57, v120
  v_sub_f32 v58, v58, v120
  v_sub_f32 v59, v59, v120
  v_sub_f32 v60, v60, v120
  v_sub_f32 v61, v61, v120
  v_sub_f32 v62, v62, v120
  v_sub_f32 v63, v63, v120
  v_sub_f32 v64, v64, v120
  v_sub_f32 v65, v65, v120
  v_sub_f32 v66, v66, v120
  v_sub_f32 v67, v67, v120
  v_sub_f32 v68, v68, v120
  v_sub_f32 v69, v69, v120
  v_sub_f32 v70, v70, v120
  v_sub_f32 v71, v71, v120
  s_cmp_lt_u32 s6, 7
  s_cbranch_scc1 L_main_kernel_42
  v_mfma_f32_32x32x16_bf16 v[24:39], a[8:11], a[0:3], v[72:87]
  s_branch L_main_kernel_43
L_main_kernel_42:
  v_mfma_f32_32x32x16_bf16 v[24:39], a[8:11], a[0:3], v[88:103]
L_main_kernel_43:
  s_mov_b64 exec, s[64:65]
  ds_read_b128 a[48:51], v123 offset:13312
  ds_read_b128 a[52:55], v123 offset:13824
  s_mov_b64 exec, -1
  v_exp_f32 v8, v8
  v_exp_f32 v9, v9
  v_exp_f32 v10, v10
  v_exp_f32 v11, v11
  v_cvt_pk_bf16_f32 v104, v8, v9
  v_exp_f32 v12, v12
  v_exp_f32 v13, v13
  v_cvt_pk_bf16_f32 v105, v10, v11
  s_add_u32 m0, s13, 98304
  s_add_u32 s14, s19, 16384
  buffer_load_dwordx4 v5, s[36:39], s14 offen lds
  v_exp_f32 v14, v14
  v_exp_f32 v15, v15
  v_cvt_pk_bf16_f32 v106, v12, v13
  v_exp_f32 v16, v16
  v_exp_f32 v17, v17
  v_cvt_pk_bf16_f32 v107, v14, v15
  v_exp_f32 v18, v18
  v_exp_f32 v19, v19
  v_cvt_pk_bf16_f32 v108, v16, v17
  s_add_u32 m0, s13, 106496
  s_add_u32 s14, s19, 49152
  buffer_load_dwordx4 v5, s[36:39], s14 offen lds
  v_exp_f32 v20, v20
  v_exp_f32 v21, v21
  v_cvt_pk_bf16_f32 v109, v18, v19
  v_exp_f32 v22, v22
  v_exp_f32 v23, v23
  v_cvt_pk_bf16_f32 v110, v20, v21
  s_waitcnt lgkmcnt(2)
  v_cvt_pk_bf16_f32 v111, v22, v23
  v_mfma_f32_32x32x16_bf16 a[56:71], a[40:43], v[104:107], 0
  s_nop 0
  v_mfma_f32_32x32x16_bf16 a[56:71], a[44:47], v[108:111], a[56:71]
  s_cmp_lt_u32 s6, 6
  s_cbranch_scc1 L_main_kernel_44
  v_mfma_f32_32x32x16_bf16 v[8:23], a[12:15], a[0:3], v[72:87]
  s_branch L_main_kernel_45
L_main_kernel_44:
  v_mfma_f32_32x32x16_bf16 v[8:23], a[12:15], a[0:3], v[88:103]
L_main_kernel_45:
  s_mov_b64 exec, s[64:65]
  ds_read_b128 a[40:43], v123 offset:14336
  ds_read_b128 a[44:47], v123 offset:14848
  s_mov_b64 exec, -1
  v_exp_f32 v24, v24
  v_exp_f32 v25, v25
  v_exp_f32 v26, v26
  v_exp_f32 v27, v27
  v_cvt_pk_bf16_f32 v112, v24, v25
  v_exp_f32 v28, v28
  v_exp_f32 v29, v29
  v_cvt_pk_bf16_f32 v113, v26, v27
  s_add_u32 m0, s13, 147456
  s_add_u32 s14, s19, 24576
  buffer_load_dwordx4 v5, s[36:39], s14 offen lds
  v_exp_f32 v30, v30
  v_exp_f32 v31, v31
  v_cvt_pk_bf16_f32 v114, v28, v29
  v_exp_f32 v32, v32
  v_exp_f32 v33, v33
  v_cvt_pk_bf16_f32 v115, v30, v31
  v_exp_f32 v34, v34
  v_exp_f32 v35, v35
  v_cvt_pk_bf16_f32 v116, v32, v33
  s_add_u32 m0, s13, 155648
  s_add_u32 s14, s19, 57344
  buffer_load_dwordx4 v5, s[36:39], s14 offen lds
  v_exp_f32 v36, v36
  v_exp_f32 v37, v37
  v_cvt_pk_bf16_f32 v117, v34, v35
  v_exp_f32 v38, v38
  v_exp_f32 v39, v39
  v_cvt_pk_bf16_f32 v118, v36, v37
  s_waitcnt lgkmcnt(2)
  v_cvt_pk_bf16_f32 v119, v38, v39
  v_mfma_f32_32x32x16_bf16 a[56:71], a[48:51], v[112:115], a[56:71]
  s_nop 0
  v_mfma_f32_32x32x16_bf16 a[56:71], a[52:55], v[116:119], a[56:71]
  s_cmp_lt_u32 s6, 5
  s_cbranch_scc1 L_main_kernel_46
  v_mfma_f32_32x32x16_bf16 v[24:39], a[16:19], a[0:3], v[72:87]
  s_branch L_main_kernel_47
L_main_kernel_46:
  v_mfma_f32_32x32x16_bf16 v[24:39], a[16:19], a[0:3], v[88:103]
L_main_kernel_47:
  s_mov_b64 exec, s[64:65]
  ds_read_b128 a[48:51], v123 offset:15360
  ds_read_b128 a[52:55], v123 offset:15872
  s_mov_b64 exec, -1
  v_exp_f32 v8, v8
  v_exp_f32 v9, v9
  v_exp_f32 v10, v10
  v_exp_f32 v11, v11
  v_cvt_pk_bf16_f32 v104, v8, v9
  v_exp_f32 v12, v12
  v_exp_f32 v13, v13
  v_cvt_pk_bf16_f32 v105, v10, v11
  s_add_u32 m0, s13, 0
  s_add_u32 s14, s19, 65536
  buffer_load_dwordx4 v5, s[36:39], s14 offen lds
  v_exp_f32 v14, v14
  v_exp_f32 v15, v15
  v_cvt_pk_bf16_f32 v106, v12, v13
  v_exp_f32 v16, v16
  v_exp_f32 v17, v17
  v_cvt_pk_bf16_f32 v107, v14, v15
  v_exp_f32 v18, v18
  v_exp_f32 v19, v19
  v_cvt_pk_bf16_f32 v108, v16, v17
  s_add_u32 m0, s13, 8192
  s_add_u32 s14, s19, 73728
  buffer_load_dwordx4 v5, s[36:39], s14 offen lds
  v_exp_f32 v20, v20
  v_exp_f32 v21, v21
  v_cvt_pk_bf16_f32 v109, v18, v19
  v_exp_f32 v22, v22
  v_exp_f32 v23, v23
  v_cvt_pk_bf16_f32 v110, v20, v21
  s_waitcnt lgkmcnt(2)
  v_cvt_pk_bf16_f32 v111, v22, v23
  v_mfma_f32_32x32x16_bf16 a[56:71], a[40:43], v[104:107], a[56:71]
  s_nop 0
  v_mfma_f32_32x32x16_bf16 a[56:71], a[44:47], v[108:111], a[56:71]
  s_cmp_lt_u32 s6, 4
  s_cbranch_scc1 L_main_kernel_48
  v_mfma_f32_32x32x16_bf16 v[8:23], a[20:23], a[0:3], v[72:87]
  s_branch L_main_kernel_49
L_main_kernel_48:
  v_mfma_f32_32x32x16_bf16 v[8:23], a[20:23], a[0:3], v[88:103]
L_main_kernel_49:
  s_mov_b64 exec, s[64:65]
  ds_read_b128 a[40:43], v123 offset:16384
  ds_read_b128 a[44:47], v123 offset:16896
  s_mov_b64 exec, -1
  v_exp_f32 v24, v24
  v_exp_f32 v25, v25
  v_exp_f32 v26, v26
  v_exp_f32 v27, v27
  v_cvt_pk_bf16_f32 v112, v24, v25
  v_exp_f32 v28, v28
  v_exp_f32 v29, v29
  v_cvt_pk_bf16_f32 v113, v26, v27
  s_add_u32 m0, s13, 16384
  s_add_u32 s14, s19, 81920
  buffer_load_dwordx4 v5, s[36:39], s14 offen lds
  v_exp_f32 v30, v30
  v_exp_f32 v31, v31
  v_cvt_pk_bf16_f32 v114, v28, v29
  v_exp_f32 v32, v32
  v_exp_f32 v33, v33
  v_cvt_pk_bf16_f32 v115, v30, v31
  v_exp_f32 v34, v34
  v_exp_f32 v35, v35
  v_cvt_pk_bf16_f32 v116, v32, v33
  s_add_u32 m0, s13, 24576
  s_add_u32 s14, s19, 90112
  buffer_load_dwordx4 v5, s[36:39], s14 offen lds
  v_exp_f32 v36, v36
  v_exp_f32 v37, v37
  v_cvt_pk_bf16_f32 v117, v34, v35
  v_exp_f32 v38, v38
  v_exp_f32 v39, v39
  v_cvt_pk_bf16_f32 v118, v36, v37
  s_waitcnt lgkmcnt(2)
  v_cvt_pk_bf16_f32 v119, v38, v39
  v_mfma_f32_32x32x16_bf16 a[56:71], a[48:51], v[112:115], a[56:71]
  s_nop 0
  v_mfma_f32_32x32x16_bf16 a[56:71], a[52:55], v[116:119], a[56:71]
  s_cmp_lt_u32 s6, 3
  s_cbranch_scc1 L_main_kernel_50
  v_mfma_f32_32x32x16_bf16 v[24:39], a[24:27], a[0:3], v[72:87]
  s_branch L_main_kernel_51
L_main_kernel_50:
  v_mfma_f32_32x32x16_bf16 v[24:39], a[24:27], a[0:3], v[88:103]
L_main_kernel_51:
  s_mov_b64 exec, s[64:65]
  ds_read_b128 a[48:51], v123 offset:17408
  ds_read_b128 a[52:55], v123 offset:17920
  s_mov_b64 exec, -1
  v_exp_f32 v8, v8
  v_exp_f32 v9, v9
  v_exp_f32 v10, v10
  v_exp_f32 v11, v11
  v_cvt_pk_bf16_f32 v104, v8, v9
  v_exp_f32 v12, v12
  v_exp_f32 v13, v13
  v_cvt_pk_bf16_f32 v105, v10, v11
  v_exp_f32 v14, v14
  v_exp_f32 v15, v15
  v_cvt_pk_bf16_f32 v106, v12, v13
  v_exp_f32 v16, v16
  v_exp_f32 v17, v17
  v_cvt_pk_bf16_f32 v107, v14, v15
  v_exp_f32 v18, v18
  v_exp_f32 v19, v19
  v_cvt_pk_bf16_f32 v108, v16, v17
  v_exp_f32 v20, v20
  v_exp_f32 v21, v21
  v_cvt_pk_bf16_f32 v109, v18, v19
  v_exp_f32 v22, v22
  v_exp_f32 v23, v23
  v_cvt_pk_bf16_f32 v110, v20, v21
  s_waitcnt lgkmcnt(2)
  v_cvt_pk_bf16_f32 v111, v22, v23
  v_mfma_f32_32x32x16_bf16 a[56:71], a[40:43], v[104:107], a[56:71]
  s_nop 0
  v_mfma_f32_32x32x16_bf16 a[56:71], a[44:47], v[108:111], a[56:71]
  s_cmp_lt_u32 s6, 2
  s_cbranch_scc1 L_main_kernel_52
  v_mfma_f32_32x32x16_bf16 v[8:23], a[28:31], a[0:3], v[72:87]
  s_branch L_main_kernel_53
L_main_kernel_52:
  v_mfma_f32_32x32x16_bf16 v[8:23], a[28:31], a[0:3], v[88:103]
L_main_kernel_53:
  s_mov_b64 exec, s[64:65]
  ds_read_b128 a[40:43], v123 offset:18432
  ds_read_b128 a[44:47], v123 offset:18944
  s_mov_b64 exec, -1
  v_exp_f32 v24, v24
  v_exp_f32 v25, v25
  v_exp_f32 v26, v26
  v_exp_f32 v27, v27
  v_cvt_pk_bf16_f32 v112, v24, v25
  v_exp_f32 v28, v28
  v_exp_f32 v29, v29
  v_cvt_pk_bf16_f32 v113, v26, v27
  v_exp_f32 v30, v30
  v_exp_f32 v31, v31
  v_cvt_pk_bf16_f32 v114, v28, v29
  v_exp_f32 v32, v32
  v_exp_f32 v33, v33
  v_cvt_pk_bf16_f32 v115, v30, v31
  v_exp_f32 v34, v34
  v_exp_f32 v35, v35
  v_cvt_pk_bf16_f32 v116, v32, v33
  v_exp_f32 v36, v36
  v_exp_f32 v37, v37
  v_cvt_pk_bf16_f32 v117, v34, v35
  v_exp_f32 v38, v38
  v_exp_f32 v39, v39
  v_cvt_pk_bf16_f32 v118, v36, v37
  s_waitcnt lgkmcnt(2)
  v_cvt_pk_bf16_f32 v119, v38, v39
  v_mfma_f32_32x32x16_bf16 a[56:71], a[48:51], v[112:115], a[56:71]
  s_nop 0
  v_mfma_f32_32x32x16_bf16 a[56:71], a[52:55], v[116:119], a[56:71]
  s_cmp_lt_u32 s6, 1
  s_cbranch_scc1 L_main_kernel_54
  v_mfma_f32_32x32x16_bf16 v[24:39], a[32:35], a[0:3], v[72:87]
  s_branch L_main_kernel_55
L_main_kernel_54:
  v_mfma_f32_32x32x16_bf16 v[24:39], a[32:35], a[0:3], v[88:103]
L_main_kernel_55:
  s_mov_b64 exec, s[64:65]
  ds_read_b128 a[48:51], v123 offset:19456
  ds_read_b128 a[52:55], v123 offset:19968
  s_mov_b64 exec, -1
  v_exp_f32 v8, v8
  v_exp_f32 v9, v9
  v_exp_f32 v10, v10
  v_exp_f32 v11, v11
  v_cvt_pk_bf16_f32 v104, v8, v9
  v_exp_f32 v12, v12
  v_exp_f32 v13, v13
  v_cvt_pk_bf16_f32 v105, v10, v11
  v_exp_f32 v14, v14
  v_exp_f32 v15, v15
  v_cvt_pk_bf16_f32 v106, v12, v13
  v_exp_f32 v16, v16
  v_exp_f32 v17, v17
  v_cvt_pk_bf16_f32 v107, v14, v15
  v_exp_f32 v18, v18
  v_exp_f32 v19, v19
  v_cvt_pk_bf16_f32 v108, v16, v17
  v_exp_f32 v20, v20
  v_exp_f32 v21, v21
  v_cvt_pk_bf16_f32 v109, v18, v19
  v_exp_f32 v22, v22
  v_exp_f32 v23, v23
  v_cvt_pk_bf16_f32 v110, v20, v21
  s_waitcnt lgkmcnt(2)
  v_cvt_pk_bf16_f32 v111, v22, v23
  v_mfma_f32_32x32x16_bf16 a[56:71], a[40:43], v[104:107], a[56:71]
  s_nop 0
  v_mfma_f32_32x32x16_bf16 a[56:71], a[44:47], v[108:111], a[56:71]
  v_mfma_f32_32x32x16_bf16 v[8:23], a[36:39], a[0:3], v[56:71]
  s_mov_b64 exec, s[64:65]
  ds_read_b128 a[40:43], v123 offset:20480
  ds_read_b128 a[44:47], v123 offset:20992
  s_mov_b64 exec, -1
  v_exp_f32 v24, v24
  v_exp_f32 v25, v25
  v_exp_f32 v26, v26
  v_exp_f32 v27, v27
  v_cvt_pk_bf16_f32 v112, v24, v25
  v_exp_f32 v28, v28
  v_exp_f32 v29, v29
  v_cvt_pk_bf16_f32 v113, v26, v27
  v_exp_f32 v30, v30
  v_exp_f32 v31, v31
  v_cvt_pk_bf16_f32 v114, v28, v29
  v_exp_f32 v32, v32
  v_exp_f32 v33, v33
  v_cvt_pk_bf16_f32 v115, v30, v31
  v_exp_f32 v34, v34
  v_exp_f32 v35, v35
  v_cvt_pk_bf16_f32 v116, v32, v33
  v_exp_f32 v36, v36
  v_exp_f32 v37, v37
  v_cvt_pk_bf16_f32 v117, v34, v35
  v_exp_f32 v38, v38
  v_exp_f32 v39, v39
  v_cvt_pk_bf16_f32 v118, v36, v37
  s_waitcnt lgkmcnt(2)
  v_cvt_pk_bf16_f32 v119, v38, v39
  v_mfma_f32_32x32x16_bf16 a[56:71], a[48:51], v[112:115], a[56:71]
  s_nop 0
  v_mfma_f32_32x32x16_bf16 a[56:71], a[52:55], v[116:119], a[56:71]
  v_exp_f32 v8, v8
  v_exp_f32 v9, v9
  v_exp_f32 v10, v10
  v_exp_f32 v11, v11
  v_cvt_pk_bf16_f32 v104, v8, v9
  v_exp_f32 v12, v12
  v_exp_f32 v13, v13
  v_cvt_pk_bf16_f32 v105, v10, v11
  v_exp_f32 v14, v14
  v_exp_f32 v15, v15
  v_cvt_pk_bf16_f32 v106, v12, v13
  v_exp_f32 v16, v16
  v_exp_f32 v17, v17
  v_cvt_pk_bf16_f32 v107, v14, v15
  v_exp_f32 v18, v18
  v_exp_f32 v19, v19
  v_cvt_pk_bf16_f32 v108, v16, v17
  v_exp_f32 v20, v20
  v_exp_f32 v21, v21
  v_cvt_pk_bf16_f32 v109, v18, v19
  v_exp_f32 v22, v22
  v_exp_f32 v23, v23
  v_cvt_pk_bf16_f32 v110, v20, v21
  s_waitcnt lgkmcnt(0)
  v_cvt_pk_bf16_f32 v111, v22, v23
  v_mfma_f32_32x32x16_bf16 a[56:71], a[40:43], v[104:107], a[56:71]
  s_nop 0
  v_mfma_f32_32x32x16_bf16 a[56:71], a[44:47], v[108:111], a[56:71]
  s_lshl_b32 s13, s6, 5
  s_add_u32 s13, s13, s7
  s_and_b32 s14, s13, 255
  s_lshl_b32 s14, s14, 2
  s_lshl_b32 s13, s13, 10
  s_add_u32 s13, s13, 0x1a00000
  s_add_u32 s14, s14, s47
  s_add_u32 s14, s14, 1024
  s_nop 6
  v_accvgpr_read_b32 v8, a56
  v_accvgpr_read_b32 v9, a57
  v_accvgpr_read_b32 v10, a58
  v_accvgpr_read_b32 v11, a59
  v_accvgpr_read_b32 v12, a60
  v_accvgpr_read_b32 v13, a61
  v_accvgpr_read_b32 v14, a62
  v_accvgpr_read_b32 v15, a63
  v_accvgpr_read_b32 v16, a64
  v_rcp_f32 v121, v16
  s_nop 0
  v_mul_f32 v8, v121, v8
  v_mul_f32 v9, v121, v9
  v_cvt_pk_bf16_f32 v104, v8, v9
  v_mul_f32 v10, v121, v10
  v_mul_f32 v11, v121, v11
  v_cvt_pk_bf16_f32 v105, v10, v11
  v_mul_f32 v12, v121, v12
  v_mul_f32 v13, v121, v13
  v_cvt_pk_bf16_f32 v106, v12, v13
  v_mul_f32 v14, v121, v14
  v_mul_f32 v15, v121, v15
  v_cvt_pk_bf16_f32 v107, v14, v15
  s_cmp_eq_u32 s44, 1
  s_cbranch_scc1 L_main_kernel_56
  buffer_store_dwordx4 v[104:107], v5, s[36:39], s13 offen sc1
  s_branch L_main_kernel_57
L_main_kernel_56:
  buffer_store_dwordx4 v[104:107], v5, s[36:39], s13 offen
L_main_kernel_57:
  s_waitcnt vmcnt(0)
  s_mov_b64 exec, 1
  s_cmp_eq_u32 s44, 1
  s_cbranch_scc1 L_main_kernel_58
  buffer_store_dword v126, v127, s[36:39], s14 offen sc1
  s_branch L_main_kernel_59
L_main_kernel_58:
  buffer_store_dword v126, v127, s[36:39], s14 offen
L_main_kernel_59:
  s_mov_b64 exec, -1
  s_and_b32 s22, s5, 3
  s_lshl_b32 s8, s4, 2
  s_add_u32 s6, s22, s8
  s_lshr_b32 s7, s5, 2
  s_lshl_b32 s13, s22, 8
  s_add_u32 s13, s13, s47
  s_add_u32 s13, s13, 1024
  s_and_b32 s17, s3, 3
  s_cmp_ge_u32 s3, 4
  s_cbranch_scc1 GL_main_kernel_60
  s_lshr_b32 s8, s17, 1
  s_and_b32 s9, s17, 1
  s_lshl_b32 s10, s6, 1
  s_add_u32 s10, s10, s8
  s_lshl_b32 s12, s7, 1
  s_add_u32 s12, s12, s9
  s_mul_i32 s11, s12, 32768
  s_lshl_b32 s14, s8, 11
  s_add_u32 s11, s11, s14
  s_add_u32 s11, s11, 0x0
  s_lshl_b32 s20, s10, 15
  s_lshl_b32 s21, s12, 11
  s_add_u32 s20, s20, s21
  s_add_u32 s20, s20, s46
  buffer_load_dwordx4 v[8:11], v5, s[36:39], s20 offen sc1
  buffer_load_dwordx4 v[12:15], v5, s[36:39], s20 offen offset:1024 sc1
  s_add_u32 s14, s11, 0
  buffer_load_dwordx4 a[0:3], v5, s[36:39], s14 offen offset:0
  s_add_u32 s14, s11, 0
  buffer_load_dwordx4 a[4:7], v5, s[36:39], s14 offen offset:1024
  s_add_u32 s14, s11, 4096
  buffer_load_dwordx4 a[8:11], v5, s[36:39], s14 offen offset:0
  s_add_u32 s14, s11, 4096
  buffer_load_dwordx4 a[12:15], v5, s[36:39], s14 offen offset:1024
  s_add_u32 s14, s11, 8192
  buffer_load_dwordx4 a[16:19], v5, s[36:39], s14 offen offset:0
  s_add_u32 s14, s11, 8192
  buffer_load_dwordx4 a[20:23], v5, s[36:39], s14 offen offset:1024
  s_add_u32 s14, s11, 12288
  buffer_load_dwordx4 a[24:27], v5, s[36:39], s14 offen offset:0
  s_add_u32 s14, s11, 12288
  buffer_load_dwordx4 a[28:31], v5, s[36:39], s14 offen offset:1024
  s_add_u32 s14, s11, 16384
  buffer_load_dwordx4 a[32:35], v5, s[36:39], s14 offen offset:0
  s_add_u32 s14, s11, 16384
  buffer_load_dwordx4 a[36:39], v5, s[36:39], s14 offen offset:1024
  s_add_u32 s14, s11, 20480
  buffer_load_dwordx4 a[40:43], v5, s[36:39], s14 offen offset:0
  s_add_u32 s14, s11, 20480
  buffer_load_dwordx4 a[44:47], v5, s[36:39], s14 offen offset:1024
  s_add_u32 s14, s11, 24576
  buffer_load_dwordx4 a[48:51], v5, s[36:39], s14 offen offset:0
  s_add_u32 s14, s11, 24576
  buffer_load_dwordx4 a[52:55], v5, s[36:39], s14 offen offset:1024
  s_add_u32 s14, s11, 28672
  buffer_load_dwordx4 a[56:59], v5, s[36:39], s14 offen offset:0
  s_add_u32 s14, s11, 28672
  buffer_load_dwordx4 a[60:63], v5, s[36:39], s14 offen offset:1024
  s_mul_i32 s14, s8, 6144
  s_xor_b32 s15, s8, 1
  s_lshl_b32 s15, s15, 12
  s_lshl_b32 s16, s8, 11
  s_add_u32 s15, s15, s16
  v_add_u32 v112, s14, v5
  v_add_u32 v116, s15, v5
  v_add_u32 v113, s14, v6
  v_add_u32 v117, s15, v6
  v_add_u32 v114, s14, v7
  v_add_u32 v118, s15, v7
  s_lshl_b32 s21, s10, 13
  s_lshl_b32 s16, s7, 10
  s_add_u32 s21, s21, s16
  s_lshl_b32 s16, s9, 3
  s_add_u32 s21, s21, s16
  s_add_u32 s21, s21, s49
  s_and_b32 s23, s10, 7
  s_lshl_b32 s23, s23, 6
  s_lshl_b32 s16, s12, 2
  s_add_u32 s23, s23, s16
  s_add_u32 s23, s23, s50
  s_add_u32 s23, s23, 512
  s_xor_b32 s16, s17, 2
  s_lshl_b32 s16, s16, 12
  v_add_u32 v120, s16, v5
  s_lshl_b32 s16, s17, 12
  v_add_u32 v121, s16, v5
  s_mov_b32 s16, 0x3f803f80
  s_waitcnt vmcnt(16)
  v_lshlrev_b32 v16, 16, v8
  v_and_b32 v17, 0xffff0000, v8
  v_lshlrev_b32 v18, 16, v9
  v_and_b32 v19, 0xffff0000, v9
  v_lshlrev_b32 v20, 16, v10
  v_and_b32 v21, 0xffff0000, v10
  v_lshlrev_b32 v22, 16, v11
  v_and_b32 v23, 0xffff0000, v11
  v_lshlrev_b32 v24, 16, v12
  v_and_b32 v25, 0xffff0000, v12
  v_lshlrev_b32 v26, 16, v13
  v_and_b32 v27, 0xffff0000, v13
  v_lshlrev_b32 v28, 16, v14
  v_and_b32 v29, 0xffff0000, v14
  v_lshlrev_b32 v30, 16, v15
  v_and_b32 v31, 0xffff0000, v15
  s_barrier
  s_waitcnt lgkmcnt(0)
  s_barrier
  ds_read_b128 v[48:51], v112 offset:32768
  ds_read_b128 v[52:55], v116 offset:32768
  ds_read_b128 v[56:59], v112 offset:33792
  ds_read_b128 v[60:63], v116 offset:33792
  ds_read_b128 v[64:67], v112 offset:40960
  ds_read_b128 v[68:71], v116 offset:40960
  s_waitcnt vmcnt(15)
  s_waitcnt lgkmcnt(4)
  v_mfma_f32_32x32x16_bf16 v[16:31], a[0:3], v[48:51], v[16:31]
  v_mfma_f32_32x32x16_bf16 v[32:47], a[0:3], v[52:55], 0
  ds_read_b128 v[48:51], v112 offset:41984
  ds_read_b128 v[52:55], v116 offset:41984
  s_waitcnt vmcnt(14)
  s_waitcnt lgkmcnt(4)
  v_mfma_f32_32x32x16_bf16 v[16:31], a[4:7], v[56:59], v[16:31]
  v_mfma_f32_32x32x16_bf16 v[32:47], a[4:7], v[60:63], v[32:47]
  s_waitcnt lgkmcnt(0)
  s_barrier
  ds_read_b128 v[56:59], v112 offset:49152
  ds_read_b128 v[60:63], v116 offset:49152
  s_waitcnt vmcnt(13)
  v_mfma_f32_32x32x16_bf16 v[16:31], a[8:11], v[64:67], v[16:31]
  v_mfma_f32_32x32x16_bf16 v[32:47], a[8:11], v[68:71], v[32:47]
  ds_read_b128 v[64:67], v112 offset:50176
  ds_read_b128 v[68:71], v116 offset:50176
  s_waitcnt vmcnt(12)
  v_mfma_f32_32x32x16_bf16 v[16:31], a[12:15], v[48:51], v[16:31]
  v_mfma_f32_32x32x16_bf16 v[32:47], a[12:15], v[52:55], v[32:47]
  ds_read_b128 v[48:51], v112 offset:57344
  ds_read_b128 v[52:55], v116 offset:57344
  s_waitcnt vmcnt(11)
  s_waitcnt lgkmcnt(4)
  v_mfma_f32_32x32x16_bf16 v[16:31], a[16:19], v[56:59], v[16:31]
  v_mfma_f32_32x32x16_bf16 v[32:47], a[16:19], v[60:63], v[32:47]
  ds_read_b128 v[56:59], v112 offset:58368
  ds_read_b128 v[60:63], v116 offset:58368
  s_waitcnt vmcnt(10)
  s_waitcnt lgkmcnt(4)
  v_mfma_f32_32x32x16_bf16 v[16:31], a[20:23], v[64:67], v[16:31]
  v_mfma_f32_32x32x16_bf16 v[32:47], a[20:23], v[68:71], v[32:47]
  s_waitcnt lgkmcnt(0)
  s_barrier
  ds_read_b128 v[64:67], v113 offset:49152
  ds_read_b128 v[68:71], v117 offset:49152
  s_waitcnt vmcnt(9)
  v_mfma_f32_32x32x16_bf16 v[16:31], a[24:27], v[48:51], v[16:31]
  v_mfma_f32_32x32x16_bf16 v[32:47], a[24:27], v[52:55], v[32:47]
  ds_read_b128 v[48:51], v113 offset:50176
  ds_read_b128 v[52:55], v117 offset:50176
  s_waitcnt vmcnt(8)
  v_mfma_f32_32x32x16_bf16 v[16:31], a[28:31], v[56:59], v[16:31]
  v_mfma_f32_32x32x16_bf16 v[32:47], a[28:31], v[60:63], v[32:47]
  ds_read_b128 v[56:59], v113 offset:57344
  ds_read_b128 v[60:63], v117 offset:57344
  s_waitcnt vmcnt(7)
  s_waitcnt lgkmcnt(4)
  v_mfma_f32_32x32x16_bf16 v[16:31], a[32:35], v[64:67], v[16:31]
  v_mfma_f32_32x32x16_bf16 v[32:47], a[32:35], v[68:71], v[32:47]
  ds_read_b128 v[64:67], v113 offset:58368
  ds_read_b128 v[68:71], v117 offset:58368
  s_waitcnt vmcnt(6)
  s_waitcnt lgkmcnt(4)
  v_mfma_f32_32x32x16_bf16 v[16:31], a[36:39], v[48:51], v[16:31]
  v_mfma_f32_32x32x16_bf16 v[32:47], a[36:39], v[52:55], v[32:47]
  s_waitcnt lgkmcnt(0)
  s_barrier
  ds_read_b128 v[48:51], v114 offset:0
  ds_read_b128 v[52:55], v118 offset:0
  s_waitcnt vmcnt(5)
  v_mfma_f32_32x32x16_bf16 v[16:31], a[40:43], v[56:59], v[16:31]
  v_mfma_f32_32x32x16_bf16 v[32:47], a[40:43], v[60:63], v[32:47]
  ds_read_b128 v[56:59], v114 offset:1024
  ds_read_b128 v[60:63], v118 offset:1024
  s_waitcnt vmcnt(4)
  v_mfma_f32_32x32x16_bf16 v[16:31], a[44:47], v[64:67], v[16:31]
  v_mfma_f32_32x32x16_bf16 v[32:47], a[44:47], v[68:71], v[32:47]
  ds_read_b128 v[64:67], v114 offset:8192
  ds_read_b128 v[68:71], v118 offset:8192
  s_waitcnt vmcnt(3)
  s_waitcnt lgkmcnt(4)
  v_mfma_f32_32x32x16_bf16 v[16:31], a[48:51], v[48:51], v[16:31]
  v_mfma_f32_32x32x16_bf16 v[32:47], a[48:51], v[52:55], v[32:47]
  ds_read_b128 v[48:51], v114 offset:9216
  ds_read_b128 v[52:55], v118 offset:9216
  s_waitcnt vmcnt(2)
  s_waitcnt lgkmcnt(4)
  v_mfma_f32_32x32x16_bf16 v[16:31], a[52:55], v[56:59], v[16:31]
  v_mfma_f32_32x32x16_bf16 v[32:47], a[52:55], v[60:63], v[32:47]
  s_waitcnt vmcnt(1)
  s_waitcnt lgkmcnt(2)
  v_mfma_f32_32x32x16_bf16 v[16:31], a[56:59], v[64:67], v[16:31]
  v_mfma_f32_32x32x16_bf16 v[32:47], a[56:59], v[68:71], v[32:47]
  s_waitcnt vmcnt(0)
  s_waitcnt lgkmcnt(0)
  v_mfma_f32_32x32x16_bf16 v[16:31], a[60:63], v[48:51], v[16:31]
  v_mfma_f32_32x32x16_bf16 v[32:47], a[60:63], v[52:55], v[32:47]
  s_barrier
  s_nop 11
  ds_write_b128 v120, v[32:35] offset:32768
  ds_write_b128 v120, v[36:39] offset:33792
  ds_write_b128 v120, v[40:43] offset:34816
  ds_write_b128 v120, v[44:47] offset:35840
  s_waitcnt lgkmcnt(0)
  s_barrier
  ds_read_b128 v[32:35], v121 offset:32768
  ds_read_b128 v[36:39], v121 offset:33792
  ds_read_b128 v[40:43], v121 offset:34816
  ds_read_b128 v[44:47], v121 offset:35840
  s_waitcnt lgkmcnt(3)
  v_add_f32 v16, v16, v32
  v_add_f32 v17, v17, v33
  v_add_f32 v18, v18, v34
  v_add_f32 v19, v19, v35
  s_waitcnt lgkmcnt(2)
  v_add_f32 v20, v20, v36
  v_add_f32 v21, v21, v37
  v_add_f32 v22, v22, v38
  v_add_f32 v23, v23, v39
  s_waitcnt lgkmcnt(1)
  v_add_f32 v24, v24, v40
  v_add_f32 v25, v25, v41
  v_add_f32 v26, v26, v42
  v_add_f32 v27, v27, v43
  s_waitcnt lgkmcnt(0)
  v_add_f32 v28, v28, v44
  v_add_f32 v29, v29, v45
  v_add_f32 v30, v30, v46
  v_add_f32 v31, v31, v47
  s_barrier
  v_cvt_pk_bf16_f32 v8, v16, v17
  v_cvt_pk_bf16_f32 v9, v18, v19
  v_cvt_pk_bf16_f32 v10, v20, v21
  v_cvt_pk_bf16_f32 v11, v22, v23
  v_cvt_pk_bf16_f32 v12, v24, v25
  v_cvt_pk_bf16_f32 v13, v26, v27
  v_cvt_pk_bf16_f32 v14, v28, v29
  v_cvt_pk_bf16_f32 v15, v30, v31
  s_cmp_eq_u32 s44, 1
  s_cbranch_scc1 L_main_kernel_63
  buffer_store_dwordx4 v[8:11], v5, s[36:39], s20 offen sc1
  buffer_store_dwordx4 v[12:15], v5, s[36:39], s20 offen offset:1024 sc1
  s_branch L_main_kernel_64
L_main_kernel_63:
  buffer_store_dwordx4 v[8:11], v5, s[36:39], s20 offen
  buffer_store_dwordx4 v[12:15], v5, s[36:39], s20 offen offset:1024
L_main_kernel_64:
  v_mov_b32 v122, 0
  v_mov_b32 v123, 0
  v_dot2_f32_bf16 v122, v8, s16, v122
  v_dot2_f32_bf16 v123, v8, v8, v123
  v_dot2_f32_bf16 v122, v9, s16, v122
  v_dot2_f32_bf16 v123, v9, v9, v123
  v_dot2_f32_bf16 v122, v10, s16, v122
  v_dot2_f32_bf16 v123, v10, v10, v123
  v_dot2_f32_bf16 v122, v11, s16, v122
  v_dot2_f32_bf16 v123, v11, v11, v123
  v_dot2_f32_bf16 v122, v12, s16, v122
  v_dot2_f32_bf16 v123, v12, v12, v123
  v_dot2_f32_bf16 v122, v13, s16, v122
  v_dot2_f32_bf16 v123, v13, v13, v123
  v_dot2_f32_bf16 v122, v14, s16, v122
  v_dot2_f32_bf16 v123, v14, v14, v123
  v_dot2_f32_bf16 v122, v15, s16, v122
  v_dot2_f32_bf16 v123, v15, v15, v123
  s_nop 2
  s_cmp_eq_u32 s44, 1
  s_cbranch_scc1 L_main_kernel_65
  buffer_store_dwordx2 v[122:123], v5, s[36:39], s21 offen sc1
  s_branch L_main_kernel_66
L_main_kernel_65:
  buffer_store_dwordx2 v[122:123], v5, s[36:39], s21 offen
L_main_kernel_66:
  s_waitcnt vmcnt(0)
  s_mov_b64 exec, 1
  s_cmp_eq_u32 s44, 1
  s_cbranch_scc1 L_main_kernel_67
  buffer_store_dword v126, v127, s[36:39], s23 offen sc1
  s_branch L_main_kernel_68
L_main_kernel_67:
  buffer_store_dword v126, v127, s[36:39], s23 offen
L_main_kernel_68:
  s_mov_b64 exec, -1
  s_branch GD_main_kernel_61
GL_main_kernel_60:
  s_mov_b32 s9, s17
  s_lshr_b32 s8, s9, 1
  s_and_b32 s12, s9, 1
  s_lshl_b32 s10, s9, 11
  s_lshl_b32 s12, s12, 11
  s_lshl_b32 s11, s6, 1
  s_add_u32 s11, s11, s8
  s_mul_i32 s11, s11, 32768
  s_add_u32 s11, s11, s12
  s_add_u32 s11, s11, 0x1a00000
  s_barrier
  s_add_u32 s31, s54, 1
  s_mov_b32 s53, 0
L_main_kernel_69:
  buffer_load_dword v8, v125, s[36:39], s13 offen sc1
  s_add_u32 s53, s53, 1
  s_waitcnt vmcnt(0)
  v_subrev_u32 v8, s31, v8
  v_cmp_lt_u32 vcc, 15, v8
  s_cbranch_vccz L_main_kernel_70
  s_cmp_lt_u32 s53, 400000
  s_cbranch_scc1 L_main_kernel_69
L_main_kernel_70:
  s_add_u32 m0, s10, 32768
  s_add_u32 s8, s11, 0
  buffer_load_dwordx4 v5, s[36:39], s8 offen sc1 lds
  buffer_load_dwordx4 v5, s[36:39], s8 offen offset:1024 sc1 lds
  s_add_u32 m0, s10, 40960
  s_add_u32 s8, s11, 4096
  buffer_load_dwordx4 v5, s[36:39], s8 offen sc1 lds
  buffer_load_dwordx4 v5, s[36:39], s8 offen offset:1024 sc1 lds
  s_add_u32 m0, s10, 49152
  s_add_u32 s8, s11, 8192
  buffer_load_dwordx4 v5, s[36:39], s8 offen sc1 lds
  buffer_load_dwordx4 v5, s[36:39], s8 offen offset:1024 sc1 lds
  s_add_u32 m0, s10, 57344
  s_add_u32 s8, s11, 12288
  buffer_load_dwordx4 v5, s[36:39], s8 offen sc1 lds
  buffer_load_dwordx4 v5, s[36:39], s8 offen offset:1024 sc1 lds
  s_add_u32 m0, s10, 114688
  s_add_u32 s8, s11, 16384
  buffer_load_dwordx4 v5, s[36:39], s8 offen sc1 lds
  buffer_load_dwordx4 v5, s[36:39], s8 offen offset:1024 sc1 lds
  s_add_u32 m0, s10, 122880
  s_add_u32 s8, s11, 20480
  buffer_load_dwordx4 v5, s[36:39], s8 offen sc1 lds
  buffer_load_dwordx4 v5, s[36:39], s8 offen offset:1024 sc1 lds
  s_add_u32 m0, s10, 131072
  s_add_u32 s8, s11, 24576
  buffer_load_dwordx4 v5, s[36:39], s8 offen sc1 lds
  buffer_load_dwordx4 v5, s[36:39], s8 offen offset:1024 sc1 lds
  s_add_u32 m0, s10, 139264
  s_add_u32 s8, s11, 28672
  buffer_load_dwordx4 v5, s[36:39], s8 offen sc1 lds
  buffer_load_dwordx4 v5, s[36:39], s8 offen offset:1024 sc1 lds
  s_waitcnt vmcnt(14)
  s_waitcnt vmcnt(12)
  s_barrier
  s_waitcnt vmcnt(10)
  s_waitcnt vmcnt(8)
  s_barrier
  s_waitcnt vmcnt(6)
  s_waitcnt vmcnt(4)
  s_barrier
  s_waitcnt vmcnt(2)
  s_waitcnt vmcnt(0)
  s_barrier
  s_barrier
  s_barrier
  s_barrier
GD_main_kernel_61:
  s_and_b32 s6, s5, 1
  s_lshl_b32 s8, s4, 1
  s_add_u32 s21, s6, s8
  s_lshr_b32 s7, s5, 1
  s_and_b32 s9, s3, 3
  s_lshl_b32 s6, s21, 2
  s_add_u32 s6, s6, s9
  s_and_b32 s22, s6, 7
  s_lshl_b32 s13, s22, 6
  s_add_u32 s13, s13, s50
  s_add_u32 s13, s13, 512
  s_cmp_ge_u32 s3, 4
  s_cbranch_scc1 RL_main_kernel_71
  s_lshl_b32 s14, s9, 11
  s_add_u32 s14, s14, 57344
  v_add_u32 v124, s14, v5
  s_mul_i32 s12, s7, 7168
  s_add_u32 s12, s12, 0x5c0000
  v_lshlrev_b32 v15, 3, v3
  v_lshl_add_u32 v15, v4, 9, v15
  buffer_load_dwordx2 v[96:97], v15, s[36:39], s12 offen offset:0
  buffer_load_dwordx2 v[98:99], v15, s[36:39], s12 offen offset:256
  buffer_load_dwordx2 v[100:101], v15, s[36:39], s12 offen offset:1024
  buffer_load_dwordx2 v[102:103], v15, s[36:39], s12 offen offset:1280
  buffer_load_dwordx2 v[104:105], v15, s[36:39], s12 offen offset:2048
  buffer_load_dwordx2 v[106:107], v15, s[36:39], s12 offen offset:2304
  buffer_load_dwordx2 v[108:109], v15, s[36:39], s12 offen offset:3072
  buffer_load_dwordx2 v[110:111], v15, s[36:39], s12 offen offset:3328
  s_add_u32 s12, s12, 4096
  buffer_load_dwordx2 v[112:113], v15, s[36:39], s12 offen offset:0
  buffer_load_dwordx2 v[114:115], v15, s[36:39], s12 offen offset:256
  buffer_load_dwordx2 v[116:117], v15, s[36:39], s12 offen offset:1024
  buffer_load_dwordx2 v[118:119], v15, s[36:39], s12 offen offset:1280
  buffer_load_dwordx2 v[120:121], v15, s[36:39], s12 offen offset:2048
  buffer_load_dwordx2 v[122:123], v15, s[36:39], s12 offen offset:2304
  s_lshl_b32 s8, s6, 15
  s_add_u32 s8, s8, s46
  s_mul_i32 s16, s6, 112
  s_add_u32 s16, s16, s7
  s_lshl_b32 s16, s16, 10
  s_add_u32 s16, s16, 0x1c00000
  v_and_b32 v1, 7, v2
  v_lshlrev_b32 v1, 7, v1
  v_lshrrev_b32 v14, 3, v2
  v_lshl_add_u32 v1, v14, 14, v1
  s_mov_b32 exec_lo, 0xffff
  s_mov_b32 exec_hi, 0
  s_add_u32 s31, s54, 1
  s_mov_b32 s53, 0
L_main_kernel_73:
  buffer_load_dword v14, v125, s[36:39], s13 offen sc1
  s_add_u32 s53, s53, 1
  s_waitcnt vmcnt(0)
  v_subrev_u32 v14, s31, v14
  v_cmp_lt_u32 vcc, 15, v14
  s_cbranch_vccz L_main_kernel_74
  s_cmp_lt_u32 s53, 400000
  s_cbranch_scc1 L_main_kernel_73
L_main_kernel_74:
  s_mov_b64 exec, -1
  buffer_load_dwordx4 a[0:3], v5, s[36:39], s8 offen offset:0 sc1
  buffer_load_dwordx4 a[4:7], v5, s[36:39], s8 offen offset:1024 sc1
  buffer_load_dwordx4 a[8:11], v5, s[36:39], s8 offen offset:2048 sc1
  buffer_load_dwordx4 a[12:15], v5, s[36:39], s8 offen offset:3072 sc1
  s_add_u32 s8, s8, 4096
  buffer_load_dwordx4 a[16:19], v5, s[36:39], s8 offen offset:0 sc1
  buffer_load_dwordx4 a[20:23], v5, s[36:39], s8 offen offset:1024 sc1
  buffer_load_dwordx4 a[24:27], v5, s[36:39], s8 offen offset:2048 sc1
  buffer_load_dwordx4 a[28:31], v5, s[36:39], s8 offen offset:3072 sc1
  s_add_u32 s8, s8, 4096
  buffer_load_dwordx4 a[32:35], v5, s[36:39], s8 offen offset:0 sc1
  buffer_load_dwordx4 a[36:39], v5, s[36:39], s8 offen offset:1024 sc1
  buffer_load_dwordx4 a[40:43], v5, s[36:39], s8 offen offset:2048 sc1
  buffer_load_dwordx4 a[44:47], v5, s[36:39], s8 offen offset:3072 sc1
  s_add_u32 s8, s8, 4096
  buffer_load_dwordx4 a[48:51], v5, s[36:39], s8 offen offset:0 sc1
  buffer_load_dwordx4 a[52:55], v5, s[36:39], s8 offen offset:1024 sc1
  buffer_load_dwordx4 a[56:59], v5, s[36:39], s8 offen offset:2048 sc1
  buffer_load_dwordx4 a[60:63], v5, s[36:39], s8 offen offset:3072 sc1
  s_waitcnt lgkmcnt(0)
  s_barrier
  ds_read_b128 v[16:19], v6 offset:0
  ds_read_b128 v[20:23], v6 offset:8192
  ds_read_b128 v[24:27], v6 offset:1024
  ds_read_b128 v[28:31], v6 offset:9216
  s_waitcnt vmcnt(15)
  s_waitcnt lgkmcnt(3)
  v_mfma_f32_32x32x16_bf16 v[32:47], v[16:19], a[0:3], 0
  s_add_u32 s8, s8, 4096
  buffer_load_dwordx4 a[64:67], v5, s[36:39], s8 offen offset:0 sc1
  ds_read_b128 v[16:19], v6 offset:2048
  s_waitcnt lgkmcnt(3)
  v_mfma_f32_32x32x16_bf16 v[48:63], v[20:23], a[0:3], 0
  buffer_load_dwordx4 a[68:71], v5, s[36:39], s8 offen offset:1024 sc1
  ds_read_b128 v[20:23], v6 offset:10240
  s_waitcnt vmcnt(16)
  s_waitcnt lgkmcnt(3)
  v_mfma_f32_32x32x16_bf16 v[32:47], v[24:27], a[4:7], v[32:47]
  buffer_load_dwordx4 a[72:75], v5, s[36:39], s8 offen offset:2048 sc1
  ds_read_b128 v[24:27], v6 offset:3072
  s_waitcnt lgkmcnt(3)
  v_mfma_f32_32x32x16_bf16 v[48:63], v[28:31], a[4:7], v[48:63]
  buffer_load_dwordx4 a[76:79], v5, s[36:39], s8 offen offset:3072 sc1
  ds_read_b128 v[28:31], v6 offset:11264
  s_waitcnt vmcnt(17)
  s_waitcnt lgkmcnt(3)
  v_mfma_f32_32x32x16_bf16 v[32:47], v[16:19], a[8:11], v[32:47]
  s_add_u32 s8, s8, 4096
  buffer_load_dwordx4 a[80:83], v5, s[36:39], s8 offen offset:0 sc1
  ds_read_b128 v[16:19], v6 offset:4096
  s_waitcnt lgkmcnt(3)
  v_mfma_f32_32x32x16_bf16 v[48:63], v[20:23], a[8:11], v[48:63]
  buffer_load_dwordx4 a[84:87], v5, s[36:39], s8 offen offset:1024 sc1
  ds_read_b128 v[20:23], v6 offset:12288
  s_waitcnt vmcnt(18)
  s_waitcnt lgkmcnt(3)
  v_mfma_f32_32x32x16_bf16 v[32:47], v[24:27], a[12:15], v[32:47]
  buffer_load_dwordx4 a[88:91], v5, s[36:39], s8 offen offset:2048 sc1
  ds_read_b128 v[24:27], v6 offset:5120
  s_waitcnt lgkmcnt(3)
  v_mfma_f32_32x32x16_bf16 v[48:63], v[28:31], a[12:15], v[48:63]
  buffer_load_dwordx4 a[92:95], v5, s[36:39], s8 offen offset:3072 sc1
  ds_read_b128 v[28:31], v6 offset:13312
  s_waitcnt vmcnt(19)
  s_waitcnt lgkmcnt(3)
  v_mfma_f32_32x32x16_bf16 v[32:47], v[16:19], a[16:19], v[32:47]
  s_add_u32 s8, s8, 4096
  buffer_load_dwordx4 a[96:99], v5, s[36:39], s8 offen offset:0 sc1
  ds_read_b128 v[16:19], v6 offset:6144
  s_waitcnt lgkmcnt(3)
  v_mfma_f32_32x32x16_bf16 v[48:63], v[20:23], a[16:19], v[48:63]
  buffer_load_dwordx4 a[100:103], v5, s[36:39], s8 offen offset:1024 sc1
  ds_read_b128 v[20:23], v6 offset:14336
  s_waitcnt vmcnt(20)
  s_waitcnt lgkmcnt(3)
  v_mfma_f32_32x32x16_bf16 v[32:47], v[24:27], a[20:23], v[32:47]
  buffer_load_dwordx4 a[104:107], v5, s[36:39], s8 offen offset:2048 sc1
  ds_read_b128 v[24:27], v6 offset:7168
  s_waitcnt lgkmcnt(3)
  v_mfma_f32_32x32x16_bf16 v[48:63], v[28:31], a[20:23], v[48:63]
  buffer_load_dwordx4 a[108:111], v5, s[36:39], s8 offen offset:3072 sc1
  ds_read_b128 v[28:31], v6 offset:15360
  s_waitcnt vmcnt(21)
  s_waitcnt lgkmcnt(3)
  v_mfma_f32_32x32x16_bf16 v[32:47], v[16:19], a[24:27], v[32:47]
  s_add_u32 s8, s8, 4096
  buffer_load_dwordx4 a[112:115], v5, s[36:39], s8 offen offset:0 sc1
  s_waitcnt lgkmcnt(0)
  s_barrier
  ds_read_b128 v[16:19], v6 offset:16384
  v_mfma_f32_32x32x16_bf16 v[48:63], v[20:23], a[24:27], v[48:63]
  buffer_load_dwordx4 a[116:119], v5, s[36:39], s8 offen offset:1024 sc1
  ds_read_b128 v[20:23], v6 offset:24576
  s_waitcnt vmcnt(22)
  v_mfma_f32_32x32x16_bf16 v[32:47], v[24:27], a[28:31], v[32:47]
  buffer_load_dwordx4 a[120:123], v5, s[36:39], s8 offen offset:2048 sc1
  ds_read_b128 v[24:27], v6 offset:17408
  v_mfma_f32_32x32x16_bf16 v[48:63], v[28:31], a[28:31], v[48:63]
  buffer_load_dwordx4 a[124:127], v5, s[36:39], s8 offen offset:3072 sc1
  ds_read_b128 v[28:31], v6 offset:25600
  s_waitcnt vmcnt(23)
  s_waitcnt lgkmcnt(3)
  v_mfma_f32_32x32x16_bf16 v[32:47], v[16:19], a[32:35], v[32:47]
  ds_read_b128 v[16:19], v6 offset:18432
  s_waitcnt lgkmcnt(3)
  v_mfma_f32_32x32x16_bf16 v[48:63], v[20:23], a[32:35], v[48:63]
  ds_read_b128 v[20:23], v6 offset:26624
  s_waitcnt vmcnt(22)
  s_waitcnt lgkmcnt(3)
  v_mfma_f32_32x32x16_bf16 v[32:47], v[24:27], a[36:39], v[32:47]
  ds_read_b128 v[24:27], v6 offset:19456
  s_waitcnt lgkmcnt(3)
  v_mfma_f32_32x32x16_bf16 v[48:63], v[28:31], a[36:39], v[48:63]
  ds_read_b128 v[28:31], v6 offset:27648
  s_waitcnt vmcnt(21)
  s_waitcnt lgkmcnt(3)
  v_mfma_f32_32x32x16_bf16 v[32:47], v[16:19], a[40:43], v[32:47]
  ds_read_b128 v[16:19], v6 offset:20480
  s_waitcnt lgkmcnt(3)
  v_mfma_f32_32x32x16_bf16 v[48:63], v[20:23], a[40:43], v[48:63]
  ds_read_b128 v[20:23], v6 offset:28672
  s_waitcnt vmcnt(20)
  s_waitcnt lgkmcnt(3)
  v_mfma_f32_32x32x16_bf16 v[32:47], v[24:27], a[44:47], v[32:47]
  ds_read_b128 v[24:27], v6 offset:21504
  s_waitcnt lgkmcnt(3)
  v_mfma_f32_32x32x16_bf16 v[48:63], v[28:31], a[44:47], v[48:63]
  ds_read_b128 v[28:31], v6 offset:29696
  s_waitcnt vmcnt(19)
  s_waitcnt lgkmcnt(3)
  v_mfma_f32_32x32x16_bf16 v[32:47], v[16:19], a[48:51], v[32:47]
  ds_read_b128 v[16:19], v6 offset:22528
  s_waitcnt lgkmcnt(3)
  v_mfma_f32_32x32x16_bf16 v[48:63], v[20:23], a[48:51], v[48:63]
  ds_read_b128 v[20:23], v6 offset:30720
  s_waitcnt vmcnt(18)
  s_waitcnt lgkmcnt(3)
  v_mfma_f32_32x32x16_bf16 v[32:47], v[24:27], a[52:55], v[32:47]
  ds_read_b128 v[24:27], v6 offset:23552
  s_waitcnt lgkmcnt(3)
  v_mfma_f32_32x32x16_bf16 v[48:63], v[28:31], a[52:55], v[48:63]
  ds_read_b128 v[28:31], v6 offset:31744
  s_waitcnt vmcnt(17)
  s_waitcnt lgkmcnt(3)
  v_mfma_f32_32x32x16_bf16 v[32:47], v[16:19], a[56:59], v[32:47]
  s_waitcnt lgkmcnt(0)
  s_barrier
  ds_read_b128 v[16:19], v6 offset:32768
  v_mfma_f32_32x32x16_bf16 v[48:63], v[20:23], a[56:59], v[48:63]
  ds_read_b128 v[20:23], v6 offset:40960
  s_waitcnt vmcnt(16)
  v_mfma_f32_32x32x16_bf16 v[32:47], v[24:27], a[60:63], v[32:47]
  ds_read_b128 v[24:27], v6 offset:33792
  v_mfma_f32_32x32x16_bf16 v[48:63], v[28:31], a[60:63], v[48:63]
  ds_read_b128 v[28:31], v6 offset:41984
  s_waitcnt vmcnt(15)
  s_waitcnt lgkmcnt(3)
  v_mfma_f32_32x32x16_bf16 v[32:47], v[16:19], a[64:67], v[32:47]
  ds_read_b128 v[16:19], v6 offset:34816
  s_waitcnt lgkmcnt(3)
  v_mfma_f32_32x32x16_bf16 v[48:63], v[20:23], a[64:67], v[48:63]
  ds_read_b128 v[20:23], v6 offset:43008
  s_waitcnt vmcnt(14)
  s_waitcnt lgkmcnt(3)
  v_mfma_f32_32x32x16_bf16 v[32:47], v[24:27], a[68:71], v[32:47]
  ds_read_b128 v[24:27], v6 offset:35840
  s_waitcnt lgkmcnt(3)
  v_mfma_f32_32x32x16_bf16 v[48:63], v[28:31], a[68:71], v[48:63]
  ds_read_b128 v[28:31], v6 offset:44032
  s_waitcnt vmcnt(13)
  s_waitcnt lgkmcnt(3)
  v_mfma_f32_32x32x16_bf16 v[32:47], v[16:19], a[72:75], v[32:47]
  ds_read_b128 v[16:19], v6 offset:36864
  s_waitcnt lgkmcnt(3)
  v_mfma_f32_32x32x16_bf16 v[48:63], v[20:23], a[72:75], v[48:63]
  ds_read_b128 v[20:23], v6 offset:45056
  s_waitcnt vmcnt(12)
  s_waitcnt lgkmcnt(3)
  v_mfma_f32_32x32x16_bf16 v[32:47], v[24:27], a[76:79], v[32:47]
  ds_read_b128 v[24:27], v6 offset:37888
  s_waitcnt lgkmcnt(3)
  v_mfma_f32_32x32x16_bf16 v[48:63], v[28:31], a[76:79], v[48:63]
  ds_read_b128 v[28:31], v6 offset:46080
  s_waitcnt vmcnt(11)
  s_waitcnt lgkmcnt(3)
  v_mfma_f32_32x32x16_bf16 v[32:47], v[16:19], a[80:83], v[32:47]
  ds_read_b128 v[16:19], v6 offset:38912
  s_waitcnt lgkmcnt(3)
  v_mfma_f32_32x32x16_bf16 v[48:63], v[20:23], a[80:83], v[48:63]
  ds_read_b128 v[20:23], v6 offset:47104
  s_waitcnt vmcnt(10)
  s_waitcnt lgkmcnt(3)
  v_mfma_f32_32x32x16_bf16 v[32:47], v[24:27], a[84:87], v[32:47]
  ds_read_b128 v[24:27], v6 offset:39936
  s_waitcnt lgkmcnt(3)
  v_mfma_f32_32x32x16_bf16 v[48:63], v[28:31], a[84:87], v[48:63]
  ds_read_b128 v[28:31], v6 offset:48128
  s_waitcnt vmcnt(9)
  s_waitcnt lgkmcnt(3)
  v_mfma_f32_32x32x16_bf16 v[32:47], v[16:19], a[88:91], v[32:47]
  s_waitcnt lgkmcnt(0)
  s_barrier
  ds_read_b128 v[16:19], v7 offset:16384
  v_mfma_f32_32x32x16_bf16 v[48:63], v[20:23], a[88:91], v[48:63]
  ds_read_b128 v[20:23], v7 offset:24576
  s_waitcnt vmcnt(8)
  v_mfma_f32_32x32x16_bf16 v[32:47], v[24:27], a[92:95], v[32:47]
  ds_read_b128 v[24:27], v7 offset:17408
  v_mfma_f32_32x32x16_bf16 v[48:63], v[28:31], a[92:95], v[48:63]
  ds_read_b128 v[28:31], v7 offset:25600
  s_waitcnt vmcnt(7)
  s_waitcnt lgkmcnt(3)
  v_mfma_f32_32x32x16_bf16 v[32:47], v[16:19], a[96:99], v[32:47]
  ds_read_b128 v[16:19], v7 offset:18432
  s_waitcnt lgkmcnt(3)
  v_mfma_f32_32x32x16_bf16 v[48:63], v[20:23], a[96:99], v[48:63]
  ds_read_b128 v[20:23], v7 offset:26624
  s_waitcnt vmcnt(6)
  s_waitcnt lgkmcnt(3)
  v_mfma_f32_32x32x16_bf16 v[32:47], v[24:27], a[100:103], v[32:47]
  ds_read_b128 v[24:27], v7 offset:19456
  s_waitcnt lgkmcnt(3)
  v_mfma_f32_32x32x16_bf16 v[48:63], v[28:31], a[100:103], v[48:63]
  ds_read_b128 v[28:31], v7 offset:27648
  s_waitcnt vmcnt(5)
  s_waitcnt lgkmcnt(3)
  v_mfma_f32_32x32x16_bf16 v[32:47], v[16:19], a[104:107], v[32:47]
  ds_read_b128 v[16:19], v7 offset:20480
  s_waitcnt lgkmcnt(3)
  v_mfma_f32_32x32x16_bf16 v[48:63], v[20:23], a[104:107], v[48:63]
  ds_read_b128 v[20:23], v7 offset:28672
  s_waitcnt vmcnt(4)
  s_waitcnt lgkmcnt(3)
  v_mfma_f32_32x32x16_bf16 v[32:47], v[24:27], a[108:111], v[32:47]
  ds_read_b128 v[24:27], v7 offset:21504
  s_waitcnt lgkmcnt(3)
  v_mfma_f32_32x32x16_bf16 v[48:63], v[28:31], a[108:111], v[48:63]
  ds_read_b128 v[28:31], v7 offset:29696
  s_waitcnt vmcnt(3)
  s_waitcnt lgkmcnt(3)
  v_mfma_f32_32x32x16_bf16 v[32:47], v[16:19], a[112:115], v[32:47]
  ds_read_b128 v[16:19], v7 offset:22528
  s_waitcnt lgkmcnt(3)
  v_mfma_f32_32x32x16_bf16 v[48:63], v[20:23], a[112:115], v[48:63]
  ds_read_b128 v[20:23], v7 offset:30720
  s_waitcnt vmcnt(2)
  s_waitcnt lgkmcnt(3)
  v_mfma_f32_32x32x16_bf16 v[32:47], v[24:27], a[116:119], v[32:47]
  ds_read_b128 v[24:27], v7 offset:23552
  s_waitcnt lgkmcnt(3)
  v_mfma_f32_32x32x16_bf16 v[48:63], v[28:31], a[116:119], v[48:63]
  ds_read_b128 v[28:31], v7 offset:31744
  s_waitcnt vmcnt(1)
  s_waitcnt lgkmcnt(3)
  v_mfma_f32_32x32x16_bf16 v[32:47], v[16:19], a[120:123], v[32:47]
  s_waitcnt lgkmcnt(0)
  s_barrier
  ds_read_b128 v[8:11], v124
  ds_read_b64 v[12:13], v124 offset:1024
  ds_read_b128 v[16:19], v5 offset:0
  v_mfma_f32_32x32x16_bf16 v[48:63], v[20:23], a[120:123], v[48:63]
  ds_read_b128 v[20:23], v5 offset:1024
  s_waitcnt vmcnt(0)
  v_mfma_f32_32x32x16_bf16 v[32:47], v[24:27], a[124:127], v[32:47]
  ds_read_b128 v[24:27], v5 offset:2048
  v_mfma_f32_32x32x16_bf16 v[48:63], v[28:31], a[124:127], v[48:63]
  s_waitcnt lgkmcnt(3)
  v_mfma_f32_32x32x16_bf16 v[32:47], v[96:99], v[8:11], v[32:47]
  v_mfma_f32_32x32x16_bf16 v[48:63], v[100:103], v[8:11], v[48:63]
  ds_read_b128 v[28:31], v5 offset:3072
  s_waitcnt lgkmcnt(3)
  v_mfma_f32_32x32x16_bf16 v[64:79], v[16:19], a[0:3], 0
  ds_read_b128 v[16:19], v5 offset:4096
  s_waitcnt lgkmcnt(3)
  v_mfma_f32_32x32x16_bf16 v[64:79], v[20:23], a[4:7], v[64:79]
  ds_read_b128 v[20:23], v5 offset:5120
  s_waitcnt lgkmcnt(3)
  v_mfma_f32_32x32x16_bf16 v[64:79], v[24:27], a[8:11], v[64:79]
  ds_read_b128 v[24:27], v5 offset:6144
  s_waitcnt lgkmcnt(3)
  v_mfma_f32_32x32x16_bf16 v[64:79], v[28:31], a[12:15], v[64:79]
  v_mul_f32 v88, v12, v32
  v_mul_f32 v89, v12, v33
  v_mul_f32 v90, v12, v34
  v_mul_f32 v91, v12, v35
  ds_read_b128 v[28:31], v5 offset:7168
  s_waitcnt lgkmcnt(3)
  v_mfma_f32_32x32x16_bf16 v[64:79], v[16:19], a[16:19], v[64:79]
  v_mul_f32 v92, v12, v36
  v_mul_f32 v93, v12, v37
  v_mul_f32 v94, v12, v38
  v_mul_f32 v95, v12, v39
  ds_read_b128 v[16:19], v5 offset:8192
  s_waitcnt lgkmcnt(3)
  v_mfma_f32_32x32x16_bf16 v[64:79], v[20:23], a[20:23], v[64:79]
  v_exp_f32 v88, v88
  v_mul_f32 v32, v32, v40
  v_exp_f32 v89, v89
  ds_read_b128 v[20:23], v5 offset:9216
  s_waitcnt lgkmcnt(3)
  v_mfma_f32_32x32x16_bf16 v[64:79], v[24:27], a[24:27], v[64:79]
  v_mul_f32 v33, v33, v41
  v_exp_f32 v90, v90
  v_mul_f32 v34, v34, v42
  ds_read_b128 v[24:27], v5 offset:10240
  s_waitcnt lgkmcnt(3)
  v_mfma_f32_32x32x16_bf16 v[64:79], v[28:31], a[28:31], v[64:79]
  v_exp_f32 v91, v91
  v_mul_f32 v35, v35, v43
  v_exp_f32 v92, v92
  ds_read_b128 v[28:31], v5 offset:11264
  s_waitcnt lgkmcnt(3)
  v_mfma_f32_32x32x16_bf16 v[64:79], v[16:19], a[32:35], v[64:79]
  v_mul_f32 v36, v36, v44
  v_exp_f32 v93, v93
  v_mul_f32 v37, v37, v45
  ds_read_b128 v[16:19], v5 offset:12288
  s_waitcnt lgkmcnt(3)
  v_mfma_f32_32x32x16_bf16 v[64:79], v[20:23], a[36:39], v[64:79]
  v_exp_f32 v94, v94
  v_mul_f32 v38, v38, v46
  v_exp_f32 v95, v95
  ds_read_b128 v[20:23], v5 offset:13312
  s_waitcnt lgkmcnt(3)
  v_mfma_f32_32x32x16_bf16 v[64:79], v[24:27], a[40:43], v[64:79]
  v_mul_f32 v39, v39, v47
  v_fma_f32 v88, v88, v13, v13
  v_fma_f32 v89, v89, v13, v13
  v_fma_f32 v90, v90, v13, v13
  ds_read_b128 v[24:27], v5 offset:14336
  s_waitcnt lgkmcnt(3)
  v_mfma_f32_32x32x16_bf16 v[64:79], v[28:31], a[44:47], v[64:79]
  v_fma_f32 v91, v91, v13, v13
  v_fma_f32 v92, v92, v13, v13
  v_fma_f32 v93, v93, v13, v13
  v_fma_f32 v94, v94, v13, v13
  ds_read_b128 v[28:31], v5 offset:15360
  s_waitcnt lgkmcnt(3)
  v_mfma_f32_32x32x16_bf16 v[64:79], v[16:19], a[48:51], v[64:79]
  v_fma_f32 v95, v95, v13, v13
  v_rcp_f32 v88, v88
  v_rcp_f32 v89, v89
  ds_read_b128 v[16:19], v5 offset:16384
  s_waitcnt lgkmcnt(3)
  v_mfma_f32_32x32x16_bf16 v[64:79], v[20:23], a[52:55], v[64:79]
  v_rcp_f32 v90, v90
  v_rcp_f32 v91, v91
  ds_read_b128 v[20:23], v5 offset:17408
  s_waitcnt lgkmcnt(3)
  v_mfma_f32_32x32x16_bf16 v[64:79], v[24:27], a[56:59], v[64:79]
  v_rcp_f32 v92, v92
  v_rcp_f32 v93, v93
  ds_read_b128 v[24:27], v5 offset:18432
  s_waitcnt lgkmcnt(3)
  v_mfma_f32_32x32x16_bf16 v[64:79], v[28:31], a[60:63], v[64:79]
  v_rcp_f32 v94, v94
  v_rcp_f32 v95, v95
  ds_read_b128 v[28:31], v5 offset:19456
  s_waitcnt lgkmcnt(3)
  v_mfma_f32_32x32x16_bf16 v[64:79], v[16:19], a[64:67], v[64:79]
  s_nop 0
  v_mul_f32 v32, v32, v88
  v_mul_f32 v33, v33, v89
  v_cvt_pk_bf16_f32 v80, v32, v33
  ds_read_b128 v[16:19], v5 offset:20480
  s_waitcnt lgkmcnt(3)
  v_mfma_f32_32x32x16_bf16 v[64:79], v[20:23], a[68:71], v[64:79]
  v_mul_f32 v34, v34, v90
  v_mul_f32 v35, v35, v91
  v_cvt_pk_bf16_f32 v81, v34, v35
  v_mul_f32 v36, v36, v92
  ds_read_b128 v[20:23], v5 offset:21504
  s_waitcnt lgkmcnt(3)
  v_mfma_f32_32x32x16_bf16 v[64:79], v[24:27], a[72:75], v[64:79]
  v_mul_f32 v37, v37, v93
  v_cvt_pk_bf16_f32 v82, v36, v37
  v_mul_f32 v38, v38, v94
  v_mul_f32 v39, v39, v95
  ds_read_b128 v[24:27], v5 offset:22528
  s_waitcnt lgkmcnt(3)
  v_mfma_f32_32x32x16_bf16 v[64:79], v[28:31], a[76:79], v[64:79]
  v_cvt_pk_bf16_f32 v83, v38, v39
  s_lshl_b32 s15, s22, 6
  s_lshl_b32 s14, s7, 2
  s_add_u32 s15, s15, s14
  s_add_u32 s15, s15, s47
  s_add_u32 s15, s15, 2048
  s_cmp_eq_u32 s44, 1
  s_cbranch_scc1 L_main_kernel_75
  buffer_store_dwordx4 v[80:83], v5, s[36:39], s16 offen sc1
  s_branch L_main_kernel_76
L_main_kernel_75:
  buffer_store_dwordx4 v[80:83], v5, s[36:39], s16 offen
L_main_kernel_76:
  v_mul_f32 v88, v12, v48
  ds_read_b128 v[28:31], v5 offset:23552
  s_waitcnt lgkmcnt(3)
  v_mfma_f32_32x32x16_bf16 v[64:79], v[16:19], a[80:83], v[64:79]
  v_mul_f32 v89, v12, v49
  v_mul_f32 v90, v12, v50
  v_mul_f32 v91, v12, v51
  v_mul_f32 v92, v12, v52
  ds_read_b128 v[16:19], v5 offset:24576
  s_waitcnt lgkmcnt(3)
  v_mfma_f32_32x32x16_bf16 v[64:79], v[20:23], a[84:87], v[64:79]
  v_mul_f32 v93, v12, v53
  v_mul_f32 v94, v12, v54
  v_mul_f32 v95, v12, v55
  v_exp_f32 v88, v88
  ds_read_b128 v[20:23], v5 offset:25600
  s_waitcnt lgkmcnt(3)
  v_mfma_f32_32x32x16_bf16 v[64:79], v[24:27], a[88:91], v[64:79]
  v_mul_f32 v48, v48, v56
  v_exp_f32 v89, v89
  v_mul_f32 v49, v49, v57
  ds_read_b128 v[24:27], v5 offset:26624
  s_waitcnt lgkmcnt(3)
  v_mfma_f32_32x32x16_bf16 v[64:79], v[28:31], a[92:95], v[64:79]
  v_exp_f32 v90, v90
  v_mul_f32 v50, v50, v58
  v_exp_f32 v91, v91
  ds_read_b128 v[28:31], v5 offset:27648
  s_waitcnt lgkmcnt(3)
  v_mfma_f32_32x32x16_bf16 v[64:79], v[16:19], a[96:99], v[64:79]
  v_mul_f32 v51, v51, v59
  v_exp_f32 v92, v92
  v_mul_f32 v52, v52, v60
  ds_read_b128 v[16:19], v5 offset:28672
  s_waitcnt lgkmcnt(3)
  v_mfma_f32_32x32x16_bf16 v[64:79], v[20:23], a[100:103], v[64:79]
  v_exp_f32 v93, v93
  v_mul_f32 v53, v53, v61
  v_exp_f32 v94, v94
  ds_read_b128 v[20:23], v5 offset:29696
  s_waitcnt lgkmcnt(3)
  v_mfma_f32_32x32x16_bf16 v[64:79], v[24:27], a[104:107], v[64:79]
  v_mul_f32 v54, v54, v62
  v_exp_f32 v95, v95
  v_mul_f32 v55, v55, v63
  ds_read_b128 v[24:27], v5 offset:30720
  s_waitcnt lgkmcnt(3)
  v_mfma_f32_32x32x16_bf16 v[64:79], v[28:31], a[108:111], v[64:79]
  v_fma_f32 v88, v88, v13, v13
  v_fma_f32 v89, v89, v13, v13
  v_fma_f32 v90, v90, v13, v13
  v_fma_f32 v91, v91, v13, v13
  ds_read_b128 v[28:31], v5 offset:31744
  s_waitcnt lgkmcnt(3)
  v_mfma_f32_32x32x16_bf16 v[64:79], v[16:19], a[112:115], v[64:79]
  v_fma_f32 v92, v92, v13, v13
  v_fma_f32 v93, v93, v13, v13
  v_fma_f32 v94, v94, v13, v13
  v_fma_f32 v95, v95, v13, v13
  s_waitcnt lgkmcnt(0)
  s_barrier
  ds_read_b128 v[16:19], v5 offset:32768
  v_mfma_f32_32x32x16_bf16 v[64:79], v[20:23], a[116:119], v[64:79]
  v_rcp_f32 v88, v88
  v_rcp_f32 v89, v89
  ds_read_b128 v[20:23], v5 offset:33792
  v_mfma_f32_32x32x16_bf16 v[64:79], v[24:27], a[120:123], v[64:79]
  v_rcp_f32 v90, v90
  v_rcp_f32 v91, v91
  ds_read_b128 v[24:27], v5 offset:34816
  v_mfma_f32_32x32x16_bf16 v[64:79], v[28:31], a[124:127], v[64:79]
  v_rcp_f32 v92, v92
  v_rcp_f32 v93, v93
  v_rcp_f32 v94, v94
  v_rcp_f32 v95, v95
  s_nop 0
  v_mul_f32 v48, v48, v88
  v_mul_f32 v49, v49, v89
  v_cvt_pk_bf16_f32 v84, v48, v49
  v_mul_f32 v50, v50, v90
  v_mul_f32 v51, v51, v91
  v_cvt_pk_bf16_f32 v85, v50, v51
  v_mul_f32 v52, v52, v92
  v_mul_f32 v53, v53, v93
  v_cvt_pk_bf16_f32 v86, v52, v53
  v_mul_f32 v54, v54, v94
  v_mul_f32 v55, v55, v95
  v_cvt_pk_bf16_f32 v87, v54, v55
  s_add_u32 s16, s16, 16384
  s_cmp_eq_u32 s44, 1
  s_cbranch_scc1 L_main_kernel_77
  buffer_store_dwordx4 v[84:87], v5, s[36:39], s16 offen sc1
  s_branch L_main_kernel_78
L_main_kernel_77:
  buffer_store_dwordx4 v[84:87], v5, s[36:39], s16 offen
L_main_kernel_78:
  v_mfma_f32_32x32x16_bf16 v[64:79], v[104:107], v[8:11], v[64:79]
  ds_read_b128 v[28:31], v5 offset:35840
  s_waitcnt lgkmcnt(3)
  v_mfma_f32_32x32x16_bf16 v[32:47], v[16:19], a[0:3], 0
  ds_read_b128 v[16:19], v5 offset:36864
  s_waitcnt lgkmcnt(3)
  v_mfma_f32_32x32x16_bf16 v[32:47], v[20:23], a[4:7], v[32:47]
  ds_read_b128 v[20:23], v5 offset:37888
  s_waitcnt lgkmcnt(3)
  v_mfma_f32_32x32x16_bf16 v[32:47], v[24:27], a[8:11], v[32:47]
  ds_read_b128 v[24:27], v5 offset:38912
  s_waitcnt lgkmcnt(3)
  v_mfma_f32_32x32x16_bf16 v[32:47], v[28:31], a[12:15], v[32:47]
  v_mul_f32 v88, v12, v64
  v_mul_f32 v89, v12, v65
  ds_read_b128 v[28:31], v5 offset:39936
  s_waitcnt lgkmcnt(3)
  v_mfma_f32_32x32x16_bf16 v[32:47], v[16:19], a[16:19], v[32:47]
  v_mul_f32 v90, v12, v66
  v_mul_f32 v91, v12, v67
  ds_read_b128 v[16:19], v5 offset:40960
  s_waitcnt lgkmcnt(3)
  v_mfma_f32_32x32x16_bf16 v[32:47], v[20:23], a[20:23], v[32:47]
  v_mul_f32 v92, v12, v68
  v_mul_f32 v93, v12, v69
  ds_read_b128 v[20:23], v5 offset:41984
  s_waitcnt lgkmcnt(3)
  v_mfma_f32_32x32x16_bf16 v[32:47], v[24:27], a[24:27], v[32:47]
  v_mul_f32 v94, v12, v70
  v_mul_f32 v95, v12, v71
  ds_read_b128 v[24:27], v5 offset:43008
  s_waitcnt lgkmcnt(3)
  v_mfma_f32_32x32x16_bf16 v[32:47], v[28:31], a[28:31], v[32:47]
  v_exp_f32 v88, v88
  ds_read_b128 v[28:31], v5 offset:44032
  s_waitcnt lgkmcnt(3)
  v_mfma_f32_32x32x16_bf16 v[32:47], v[16:19], a[32:35], v[32:47]
  v_mul_f32 v64, v64, v72
  v_exp_f32 v89, v89
  ds_read_b128 v[16:19], v5 offset:45056
  s_waitcnt lgkmcnt(3)
  v_mfma_f32_32x32x16_bf16 v[32:47], v[20:23], a[36:39], v[32:47]
  v_mul_f32 v65, v65, v73
  v_exp_f32 v90, v90
  ds_read_b128 v[20:23], v5 offset:46080
  s_waitcnt lgkmcnt(3)
  v_mfma_f32_32x32x16_bf16 v[32:47], v[24:27], a[40:43], v[32:47]
  v_mul_f32 v66, v66, v74
  v_exp_f32 v91, v91
  ds_read_b128 v[24:27], v5 offset:47104
  s_waitcnt lgkmcnt(3)
  v_mfma_f32_32x32x16_bf16 v[32:47], v[28:31], a[44:47], v[32:47]
  v_mul_f32 v67, v67, v75
  v_exp_f32 v92, v92
  ds_read_b128 v[28:31], v5 offset:48128
  s_waitcnt lgkmcnt(3)
  v_mfma_f32_32x32x16_bf16 v[32:47], v[16:19], a[48:51], v[32:47]
  v_mul_f32 v68, v68, v76
  v_exp_f32 v93, v93
  ds_read_b128 v[16:19], v5 offset:49152
  s_waitcnt lgkmcnt(3)
  v_mfma_f32_32x32x16_bf16 v[32:47], v[20:23], a[52:55], v[32:47]
  v_mul_f32 v69, v69, v77
  v_exp_f32 v94, v94
  ds_read_b128 v[20:23], v5 offset:50176
  s_waitcnt lgkmcnt(3)
  v_mfma_f32_32x32x16_bf16 v[32:47], v[24:27], a[56:59], v[32:47]
  v_mul_f32 v70, v70, v78
  v_exp_f32 v95, v95
  ds_read_b128 v[24:27], v5 offset:51200
  s_waitcnt lgkmcnt(3)
  v_mfma_f32_32x32x16_bf16 v[32:47], v[28:31], a[60:63], v[32:47]
  v_mul_f32 v71, v71, v79
  v_fma_f32 v88, v88, v13, v13
  ds_read_b128 v[28:31], v5 offset:52224
  s_waitcnt lgkmcnt(3)
  v_mfma_f32_32x32x16_bf16 v[32:47], v[16:19], a[64:67], v[32:47]
  v_fma_f32 v89, v89, v13, v13
  v_fma_f32 v90, v90, v13, v13
  ds_read_b128 v[16:19], v5 offset:53248
  s_waitcnt lgkmcnt(3)
  v_mfma_f32_32x32x16_bf16 v[32:47], v[20:23], a[68:71], v[32:47]
  v_fma_f32 v91, v91, v13, v13
  v_fma_f32 v92, v92, v13, v13
  ds_read_b128 v[20:23], v5 offset:54272
  s_waitcnt lgkmcnt(3)
  v_mfma_f32_32x32x16_bf16 v[32:47], v[24:27], a[72:75], v[32:47]
  v_fma_f32 v93, v93, v13, v13
  v_fma_f32 v94, v94, v13, v13
  ds_read_b128 v[24:27], v5 offset:55296
  s_waitcnt lgkmcnt(3)
  v_mfma_f32_32x32x16_bf16 v[32:47], v[28:31], a[76:79], v[32:47]
  v_fma_f32 v95, v95, v13, v13
  v_rcp_f32 v88, v88
  ds_read_b128 v[28:31], v5 offset:56320
  s_waitcnt lgkmcnt(3)
  v_mfma_f32_32x32x16_bf16 v[32:47], v[16:19], a[80:83], v[32:47]
  v_rcp_f32 v89, v89
  ds_read_b128 v[16:19], v6 offset:49152
  s_waitcnt lgkmcnt(3)
  v_mfma_f32_32x32x16_bf16 v[32:47], v[20:23], a[84:87], v[32:47]
  v_rcp_f32 v90, v90
  ds_read_b128 v[20:23], v6 offset:50176
  s_waitcnt lgkmcnt(3)
  v_mfma_f32_32x32x16_bf16 v[32:47], v[24:27], a[88:91], v[32:47]
  v_rcp_f32 v91, v91
  ds_read_b128 v[24:27], v6 offset:51200
  s_waitcnt lgkmcnt(3)
  v_mfma_f32_32x32x16_bf16 v[32:47], v[28:31], a[92:95], v[32:47]
  v_rcp_f32 v92, v92
  ds_read_b128 v[28:31], v6 offset:52224
  s_waitcnt lgkmcnt(3)
  v_mfma_f32_32x32x16_bf16 v[32:47], v[16:19], a[96:99], v[32:47]
  v_rcp_f32 v93, v93
  ds_read_b128 v[16:19], v6 offset:53248
  s_waitcnt lgkmcnt(3)
  v_mfma_f32_32x32x16_bf16 v[32:47], v[20:23], a[100:103], v[32:47]
  v_rcp_f32 v94, v94
  ds_read_b128 v[20:23], v6 offset:54272
  s_waitcnt lgkmcnt(3)
  v_mfma_f32_32x32x16_bf16 v[32:47], v[24:27], a[104:107], v[32:47]
  v_rcp_f32 v95, v95
  ds_read_b128 v[24:27], v6 offset:55296
  s_waitcnt lgkmcnt(3)
  v_mfma_f32_32x32x16_bf16 v[32:47], v[28:31], a[108:111], v[32:47]
  s_nop 0
  v_mul_f32 v64, v64, v88
  ds_read_b128 v[28:31], v6 offset:56320
  s_waitcnt lgkmcnt(3)
  v_mfma_f32_32x32x16_bf16 v[32:47], v[16:19], a[112:115], v[32:47]
  v_mul_f32 v65, v65, v89
  v_cvt_pk_bf16_f32 v80, v64, v65
  s_waitcnt lgkmcnt(0)
  s_barrier
  ds_read_b128 v[16:19], v6 offset:57344
  v_mfma_f32_32x32x16_bf16 v[32:47], v[20:23], a[116:119], v[32:47]
  v_mul_f32 v66, v66, v90
  v_mul_f32 v67, v67, v91
  ds_read_b128 v[20:23], v6 offset:58368
  v_mfma_f32_32x32x16_bf16 v[32:47], v[24:27], a[120:123], v[32:47]
  v_cvt_pk_bf16_f32 v81, v66, v67
  v_mul_f32 v68, v68, v92
  ds_read_b128 v[24:27], v6 offset:59392
  v_mfma_f32_32x32x16_bf16 v[32:47], v[28:31], a[124:127], v[32:47]
  v_mul_f32 v69, v69, v93
  v_cvt_pk_bf16_f32 v82, v68, v69
  v_mul_f32 v70, v70, v94
  v_mul_f32 v71, v71, v95
  v_cvt_pk_bf16_f32 v83, v70, v71
  s_add_u32 s16, s16, 16384
  s_waitcnt vmcnt(0)
  s_add_u32 s31, s54, 2
  v_mov_b32 v14, s31
  s_mov_b64 exec, 1
  s_cmp_eq_u32 s44, 1
  s_cbranch_scc1 L_main_kernel_79
  buffer_store_dword v14, v127, s[36:39], s15 offen sc1
  s_branch L_main_kernel_80
L_main_kernel_79:
  buffer_store_dword v14, v127, s[36:39], s15 offen
L_main_kernel_80:
  s_mov_b64 exec, -1
  s_cmp_eq_u32 s44, 1
  s_cbranch_scc1 L_main_kernel_81
  buffer_store_dwordx4 v[80:83], v5, s[36:39], s16 offen sc1
  s_branch L_main_kernel_82
L_main_kernel_81:
  buffer_store_dwordx4 v[80:83], v5, s[36:39], s16 offen
L_main_kernel_82:
  v_mfma_f32_32x32x16_bf16 v[32:47], v[108:111], v[8:11], v[32:47]
  ds_read_b128 v[28:31], v6 offset:60416
  s_waitcnt lgkmcnt(3)
  v_mfma_f32_32x32x16_bf16 v[48:63], v[16:19], a[0:3], 0
  ds_read_b128 v[16:19], v6 offset:61440
  s_waitcnt lgkmcnt(3)
  v_mfma_f32_32x32x16_bf16 v[48:63], v[20:23], a[4:7], v[48:63]
  ds_read_b128 v[20:23], v6 offset:62464
  s_waitcnt lgkmcnt(3)
  v_mfma_f32_32x32x16_bf16 v[48:63], v[24:27], a[8:11], v[48:63]
  ds_read_b128 v[24:27], v6 offset:63488
  s_waitcnt lgkmcnt(3)
  v_mfma_f32_32x32x16_bf16 v[48:63], v[28:31], a[12:15], v[48:63]
  v_mul_f32 v88, v12, v32
  v_mul_f32 v89, v12, v33
  ds_read_b128 v[28:31], v6 offset:64512
  s_waitcnt lgkmcnt(3)
  v_mfma_f32_32x32x16_bf16 v[48:63], v[16:19], a[16:19], v[48:63]
  v_mul_f32 v90, v12, v34
  v_mul_f32 v91, v12, v35
  ds_read_b128 v[16:19], v7 offset:0
  s_waitcnt lgkmcnt(3)
  v_mfma_f32_32x32x16_bf16 v[48:63], v[20:23], a[20:23], v[48:63]
  v_mul_f32 v92, v12, v36
  v_mul_f32 v93, v12, v37
  ds_read_b128 v[20:23], v7 offset:1024
  s_waitcnt lgkmcnt(3)
  v_mfma_f32_32x32x16_bf16 v[48:63], v[24:27], a[24:27], v[48:63]
  v_mul_f32 v94, v12, v38
  v_mul_f32 v95, v12, v39
  ds_read_b128 v[24:27], v7 offset:2048
  s_waitcnt lgkmcnt(3)
  v_mfma_f32_32x32x16_bf16 v[48:63], v[28:31], a[28:31], v[48:63]
  v_exp_f32 v88, v88
  ds_read_b128 v[28:31], v7 offset:3072
  s_waitcnt lgkmcnt(3)
  v_mfma_f32_32x32x16_bf16 v[48:63], v[16:19], a[32:35], v[48:63]
  v_mul_f32 v32, v32, v40
  v_exp_f32 v89, v89
  ds_read_b128 v[16:19], v7 offset:4096
  s_waitcnt lgkmcnt(3)
  v_mfma_f32_32x32x16_bf16 v[48:63], v[20:23], a[36:39], v[48:63]
  v_mul_f32 v33, v33, v41
  v_exp_f32 v90, v90
  ds_read_b128 v[20:23], v7 offset:5120
  s_waitcnt lgkmcnt(3)
  v_mfma_f32_32x32x16_bf16 v[48:63], v[24:27], a[40:43], v[48:63]
  v_mul_f32 v34, v34, v42
  v_exp_f32 v91, v91
  ds_read_b128 v[24:27], v7 offset:6144
  s_waitcnt lgkmcnt(3)
  v_mfma_f32_32x32x16_bf16 v[48:63], v[28:31], a[44:47], v[48:63]
  v_mul_f32 v35, v35, v43
  v_exp_f32 v92, v92
  ds_read_b128 v[28:31], v7 offset:7168
  s_waitcnt lgkmcnt(3)
  v_mfma_f32_32x32x16_bf16 v[48:63], v[16:19], a[48:51], v[48:63]
  v_mul_f32 v36, v36, v44
  v_exp_f32 v93, v93
  ds_read_b128 v[16:19], v7 offset:8192
  s_waitcnt lgkmcnt(3)
  v_mfma_f32_32x32x16_bf16 v[48:63], v[20:23], a[52:55], v[48:63]
  v_mul_f32 v37, v37, v45
  v_exp_f32 v94, v94
  ds_read_b128 v[20:23], v7 offset:9216
  s_waitcnt lgkmcnt(3)
  v_mfma_f32_32x32x16_bf16 v[48:63], v[24:27], a[56:59], v[48:63]
  v_mul_f32 v38, v38, v46
  v_exp_f32 v95, v95
  ds_read_b128 v[24:27], v7 offset:10240
  s_waitcnt lgkmcnt(3)
  v_mfma_f32_32x32x16_bf16 v[48:63], v[28:31], a[60:63], v[48:63]
  v_mul_f32 v39, v39, v47
  v_fma_f32 v88, v88, v13, v13
  ds_read_b128 v[28:31], v7 offset:11264
  s_waitcnt lgkmcnt(3)
  v_mfma_f32_32x32x16_bf16 v[48:63], v[16:19], a[64:67], v[48:63]
  v_fma_f32 v89, v89, v13, v13
  v_fma_f32 v90, v90, v13, v13
  ds_read_b128 v[16:19], v7 offset:12288
  s_waitcnt lgkmcnt(3)
  v_mfma_f32_32x32x16_bf16 v[48:63], v[20:23], a[68:71], v[48:63]
  v_fma_f32 v91, v91, v13, v13
  v_fma_f32 v92, v92, v13, v13
  ds_read_b128 v[20:23], v7 offset:13312
  s_waitcnt lgkmcnt(3)
  v_mfma_f32_32x32x16_bf16 v[48:63], v[24:27], a[72:75], v[48:63]
  v_fma_f32 v93, v93, v13, v13
  v_fma_f32 v94, v94, v13, v13
  ds_read_b128 v[24:27], v7 offset:14336
  s_waitcnt lgkmcnt(3)
  v_mfma_f32_32x32x16_bf16 v[48:63], v[28:31], a[76:79], v[48:63]
  v_fma_f32 v95, v95, v13, v13
  v_rcp_f32 v88, v88
  ds_read_b128 v[28:31], v7 offset:15360
  s_waitcnt lgkmcnt(3)
  v_mfma_f32_32x32x16_bf16 v[48:63], v[16:19], a[80:83], v[48:63]
  v_rcp_f32 v89, v89
  ds_read_b128 v[16:19], v6 offset:0
  s_waitcnt lgkmcnt(3)
  v_mfma_f32_32x32x16_bf16 v[48:63], v[20:23], a[84:87], v[48:63]
  v_rcp_f32 v90, v90
  ds_read_b128 v[20:23], v6 offset:1024
  s_waitcnt lgkmcnt(3)
  v_mfma_f32_32x32x16_bf16 v[48:63], v[24:27], a[88:91], v[48:63]
  v_rcp_f32 v91, v91
  ds_read_b128 v[24:27], v6 offset:2048
  s_waitcnt lgkmcnt(3)
  v_mfma_f32_32x32x16_bf16 v[48:63], v[28:31], a[92:95], v[48:63]
  v_rcp_f32 v92, v92
  ds_read_b128 v[28:31], v6 offset:3072
  s_waitcnt lgkmcnt(3)
  v_mfma_f32_32x32x16_bf16 v[48:63], v[16:19], a[96:99], v[48:63]
  v_rcp_f32 v93, v93
  ds_read_b128 v[16:19], v6 offset:4096
  s_waitcnt lgkmcnt(3)
  v_mfma_f32_32x32x16_bf16 v[48:63], v[20:23], a[100:103], v[48:63]
  v_rcp_f32 v94, v94
  ds_read_b128 v[20:23], v6 offset:5120
  s_waitcnt lgkmcnt(3)
  v_mfma_f32_32x32x16_bf16 v[48:63], v[24:27], a[104:107], v[48:63]
  v_rcp_f32 v95, v95
  ds_read_b128 v[24:27], v6 offset:6144
  s_waitcnt lgkmcnt(3)
  v_mfma_f32_32x32x16_bf16 v[48:63], v[28:31], a[108:111], v[48:63]
  s_nop 0
  v_mul_f32 v32, v32, v88
  ds_read_b128 v[28:31], v6 offset:7168
  s_waitcnt lgkmcnt(3)
  v_mfma_f32_32x32x16_bf16 v[48:63], v[16:19], a[112:115], v[48:63]
  v_mul_f32 v33, v33, v89
  v_cvt_pk_bf16_f32 v84, v32, v33
  s_waitcnt lgkmcnt(0)
  s_barrier
  ds_read_b128 v[16:19], v6 offset:8192
  v_mfma_f32_32x32x16_bf16 v[48:63], v[20:23], a[116:119], v[48:63]
  v_mul_f32 v34, v34, v90
  v_mul_f32 v35, v35, v91
  ds_read_b128 v[20:23], v6 offset:9216
  v_mfma_f32_32x32x16_bf16 v[48:63], v[24:27], a[120:123], v[48:63]
  v_cvt_pk_bf16_f32 v85, v34, v35
  v_mul_f32 v36, v36, v92
  ds_read_b128 v[24:27], v6 offset:10240
  v_mfma_f32_32x32x16_bf16 v[48:63], v[28:31], a[124:127], v[48:63]
  v_mul_f32 v37, v37, v93
  v_cvt_pk_bf16_f32 v86, v36, v37
  v_mul_f32 v38, v38, v94
  v_mul_f32 v39, v39, v95
  v_cvt_pk_bf16_f32 v87, v38, v39
  s_add_u32 s16, s16, 16384
  s_waitcnt vmcnt(0)
  s_add_u32 s31, s54, 3
  v_mov_b32 v14, s31
  s_mov_b64 exec, 1
  s_cmp_eq_u32 s44, 1
  s_cbranch_scc1 L_main_kernel_83
  buffer_store_dword v14, v127, s[36:39], s15 offen sc1
  s_branch L_main_kernel_84
L_main_kernel_83:
  buffer_store_dword v14, v127, s[36:39], s15 offen
L_main_kernel_84:
  s_mov_b64 exec, -1
  s_cmp_eq_u32 s44, 1
  s_cbranch_scc1 L_main_kernel_85
  buffer_store_dwordx4 v[84:87], v5, s[36:39], s16 offen sc1
  s_branch L_main_kernel_86
L_main_kernel_85:
  buffer_store_dwordx4 v[84:87], v5, s[36:39], s16 offen
L_main_kernel_86:
  v_mfma_f32_32x32x16_bf16 v[48:63], v[112:115], v[8:11], v[48:63]
  ds_read_b128 v[28:31], v6 offset:11264
  s_waitcnt lgkmcnt(3)
  v_mfma_f32_32x32x16_bf16 v[64:79], v[16:19], a[0:3], 0
  ds_read_b128 v[16:19], v6 offset:12288
  s_waitcnt lgkmcnt(3)
  v_mfma_f32_32x32x16_bf16 v[64:79], v[20:23], a[4:7], v[64:79]
  ds_read_b128 v[20:23], v6 offset:13312
  s_waitcnt lgkmcnt(3)
  v_mfma_f32_32x32x16_bf16 v[64:79], v[24:27], a[8:11], v[64:79]
  ds_read_b128 v[24:27], v6 offset:14336
  s_waitcnt lgkmcnt(3)
  v_mfma_f32_32x32x16_bf16 v[64:79], v[28:31], a[12:15], v[64:79]
  v_mul_f32 v88, v12, v48
  v_mul_f32 v89, v12, v49
  ds_read_b128 v[28:31], v6 offset:15360
  s_waitcnt lgkmcnt(3)
  v_mfma_f32_32x32x16_bf16 v[64:79], v[16:19], a[16:19], v[64:79]
  v_mul_f32 v90, v12, v50
  v_mul_f32 v91, v12, v51
  ds_read_b128 v[16:19], v6 offset:16384
  s_waitcnt lgkmcnt(3)
  v_mfma_f32_32x32x16_bf16 v[64:79], v[20:23], a[20:23], v[64:79]
  v_mul_f32 v92, v12, v52
  v_mul_f32 v93, v12, v53
  ds_read_b128 v[20:23], v6 offset:17408
  s_waitcnt lgkmcnt(3)
  v_mfma_f32_32x32x16_bf16 v[64:79], v[24:27], a[24:27], v[64:79]
  v_mul_f32 v94, v12, v54
  v_mul_f32 v95, v12, v55
  ds_read_b128 v[24:27], v6 offset:18432
  s_waitcnt lgkmcnt(3)
  v_mfma_f32_32x32x16_bf16 v[64:79], v[28:31], a[28:31], v[64:79]
  v_exp_f32 v88, v88
  ds_read_b128 v[28:31], v6 offset:19456
  s_waitcnt lgkmcnt(3)
  v_mfma_f32_32x32x16_bf16 v[64:79], v[16:19], a[32:35], v[64:79]
  v_mul_f32 v48, v48, v56
  v_exp_f32 v89, v89
  ds_read_b128 v[16:19], v6 offset:20480
  s_waitcnt lgkmcnt(3)
  v_mfma_f32_32x32x16_bf16 v[64:79], v[20:23], a[36:39], v[64:79]
  v_mul_f32 v49, v49, v57
  v_exp_f32 v90, v90
  ds_read_b128 v[20:23], v6 offset:21504
  s_waitcnt lgkmcnt(3)
  v_mfma_f32_32x32x16_bf16 v[64:79], v[24:27], a[40:43], v[64:79]
  v_mul_f32 v50, v50, v58
  v_exp_f32 v91, v91
  ds_read_b128 v[24:27], v6 offset:22528
  s_waitcnt lgkmcnt(3)
  v_mfma_f32_32x32x16_bf16 v[64:79], v[28:31], a[44:47], v[64:79]
  v_mul_f32 v51, v51, v59
  v_exp_f32 v92, v92
  ds_read_b128 v[28:31], v6 offset:23552
  s_waitcnt lgkmcnt(3)
  v_mfma_f32_32x32x16_bf16 v[64:79], v[16:19], a[48:51], v[64:79]
  v_mul_f32 v52, v52, v60
  v_exp_f32 v93, v93
  ds_read_b128 v[16:19], v6 offset:24576
  s_waitcnt lgkmcnt(3)
  v_mfma_f32_32x32x16_bf16 v[64:79], v[20:23], a[52:55], v[64:79]
  v_mul_f32 v53, v53, v61
  v_exp_f32 v94, v94
  ds_read_b128 v[20:23], v6 offset:25600
  s_waitcnt lgkmcnt(3)
  v_mfma_f32_32x32x16_bf16 v[64:79], v[24:27], a[56:59], v[64:79]
  v_mul_f32 v54, v54, v62
  v_exp_f32 v95, v95
  ds_read_b128 v[24:27], v6 offset:26624
  s_waitcnt lgkmcnt(3)
  v_mfma_f32_32x32x16_bf16 v[64:79], v[28:31], a[60:63], v[64:79]
  v_mul_f32 v55, v55, v63
  v_fma_f32 v88, v88, v13, v13
  ds_read_b128 v[28:31], v6 offset:27648
  s_waitcnt lgkmcnt(3)
  v_mfma_f32_32x32x16_bf16 v[64:79], v[16:19], a[64:67], v[64:79]
  v_fma_f32 v89, v89, v13, v13
  v_fma_f32 v90, v90, v13, v13
  ds_read_b128 v[16:19], v6 offset:28672
  s_waitcnt lgkmcnt(3)
  v_mfma_f32_32x32x16_bf16 v[64:79], v[20:23], a[68:71], v[64:79]
  v_fma_f32 v91, v91, v13, v13
  v_fma_f32 v92, v92, v13, v13
  ds_read_b128 v[20:23], v6 offset:29696
  s_waitcnt lgkmcnt(3)
  v_mfma_f32_32x32x16_bf16 v[64:79], v[24:27], a[72:75], v[64:79]
  v_fma_f32 v93, v93, v13, v13
  v_fma_f32 v94, v94, v13, v13
  ds_read_b128 v[24:27], v6 offset:30720
  s_waitcnt lgkmcnt(3)
  v_mfma_f32_32x32x16_bf16 v[64:79], v[28:31], a[76:79], v[64:79]
  v_fma_f32 v95, v95, v13, v13
  v_rcp_f32 v88, v88
  ds_read_b128 v[28:31], v6 offset:31744
  s_waitcnt lgkmcnt(3)
  v_mfma_f32_32x32x16_bf16 v[64:79], v[16:19], a[80:83], v[64:79]
  v_rcp_f32 v89, v89
  ds_read_b128 v[16:19], v6 offset:32768
  s_waitcnt lgkmcnt(3)
  v_mfma_f32_32x32x16_bf16 v[64:79], v[20:23], a[84:87], v[64:79]
  v_rcp_f32 v90, v90
  ds_read_b128 v[20:23], v6 offset:33792
  s_waitcnt lgkmcnt(3)
  v_mfma_f32_32x32x16_bf16 v[64:79], v[24:27], a[88:91], v[64:79]
  v_rcp_f32 v91, v91
  ds_read_b128 v[24:27], v6 offset:34816
  s_waitcnt lgkmcnt(3)
  v_mfma_f32_32x32x16_bf16 v[64:79], v[28:31], a[92:95], v[64:79]
  v_rcp_f32 v92, v92
  ds_read_b128 v[28:31], v6 offset:35840
  s_waitcnt lgkmcnt(3)
  v_mfma_f32_32x32x16_bf16 v[64:79], v[16:19], a[96:99], v[64:79]
  v_rcp_f32 v93, v93
  ds_read_b128 v[16:19], v6 offset:36864
  s_waitcnt lgkmcnt(3)
  v_mfma_f32_32x32x16_bf16 v[64:79], v[20:23], a[100:103], v[64:79]
  v_rcp_f32 v94, v94
  ds_read_b128 v[20:23], v6 offset:37888
  s_waitcnt lgkmcnt(3)
  v_mfma_f32_32x32x16_bf16 v[64:79], v[24:27], a[104:107], v[64:79]
  v_rcp_f32 v95, v95
  ds_read_b128 v[24:27], v6 offset:38912
  s_waitcnt lgkmcnt(3)
  v_mfma_f32_32x32x16_bf16 v[64:79], v[28:31], a[108:111], v[64:79]
  s_nop 0
  v_mul_f32 v48, v48, v88
  ds_read_b128 v[28:31], v6 offset:39936
  s_waitcnt lgkmcnt(3)
  v_mfma_f32_32x32x16_bf16 v[64:79], v[16:19], a[112:115], v[64:79]
  v_mul_f32 v49, v49, v89
  v_cvt_pk_bf16_f32 v80, v48, v49
  s_waitcnt lgkmcnt(0)
  s_barrier
  ds_read_b128 v[16:19], v6 offset:40960
  v_mfma_f32_32x32x16_bf16 v[64:79], v[20:23], a[116:119], v[64:79]
  v_mul_f32 v50, v50, v90
  v_mul_f32 v51, v51, v91
  ds_read_b128 v[20:23], v6 offset:41984
  v_mfma_f32_32x32x16_bf16 v[64:79], v[24:27], a[120:123], v[64:79]
  v_cvt_pk_bf16_f32 v81, v50, v51
  v_mul_f32 v52, v52, v92
  ds_read_b128 v[24:27], v6 offset:43008
  v_mfma_f32_32x32x16_bf16 v[64:79], v[28:31], a[124:127], v[64:79]
  v_mul_f32 v53, v53, v93
  v_cvt_pk_bf16_f32 v82, v52, v53
  v_mul_f32 v54, v54, v94
  v_mul_f32 v55, v55, v95
  v_cvt_pk_bf16_f32 v83, v54, v55
  s_add_u32 s16, s16, 16384
  s_waitcnt vmcnt(0)
  s_add_u32 s31, s54, 4
  v_mov_b32 v14, s31
  s_mov_b64 exec, 1
  s_cmp_eq_u32 s44, 1
  s_cbranch_scc1 L_main_kernel_87
  buffer_store_dword v14, v127, s[36:39], s15 offen sc1
  s_branch L_main_kernel_88
L_main_kernel_87:
  buffer_store_dword v14, v127, s[36:39], s15 offen
L_main_kernel_88:
  s_mov_b64 exec, -1
  s_cmp_eq_u32 s44, 1
  s_cbranch_scc1 L_main_kernel_89
  buffer_store_dwordx4 v[80:83], v5, s[36:39], s16 offen sc1
  s_branch L_main_kernel_90
L_main_kernel_89:
  buffer_store_dwordx4 v[80:83], v5, s[36:39], s16 offen
L_main_kernel_90:
  v_mfma_f32_32x32x16_bf16 v[64:79], v[116:119], v[8:11], v[64:79]
  ds_read_b128 v[28:31], v6 offset:44032
  s_waitcnt lgkmcnt(3)
  v_mfma_f32_32x32x16_bf16 v[32:47], v[16:19], a[0:3], 0
  ds_read_b128 v[16:19], v6 offset:45056
  s_waitcnt lgkmcnt(3)
  v_mfma_f32_32x32x16_bf16 v[32:47], v[20:23], a[4:7], v[32:47]
  ds_read_b128 v[20:23], v6 offset:46080
  s_waitcnt lgkmcnt(3)
  v_mfma_f32_32x32x16_bf16 v[32:47], v[24:27], a[8:11], v[32:47]
  ds_read_b128 v[24:27], v6 offset:47104
  s_waitcnt lgkmcnt(3)
  v_mfma_f32_32x32x16_bf16 v[32:47], v[28:31], a[12:15], v[32:47]
  v_mul_f32 v88, v12, v64
  v_mul_f32 v89, v12, v65
  ds_read_b128 v[28:31], v6 offset:48128
  s_waitcnt lgkmcnt(3)
  v_mfma_f32_32x32x16_bf16 v[32:47], v[16:19], a[16:19], v[32:47]
  v_mul_f32 v90, v12, v66
  v_mul_f32 v91, v12, v67
  ds_read_b128 v[16:19], v7 offset:16384
  s_waitcnt lgkmcnt(3)
  v_mfma_f32_32x32x16_bf16 v[32:47], v[20:23], a[20:23], v[32:47]
  v_mul_f32 v92, v12, v68
  v_mul_f32 v93, v12, v69
  ds_read_b128 v[20:23], v7 offset:17408
  s_waitcnt lgkmcnt(3)
  v_mfma_f32_32x32x16_bf16 v[32:47], v[24:27], a[24:27], v[32:47]
  v_mul_f32 v94, v12, v70
  v_mul_f32 v95, v12, v71
  ds_read_b128 v[24:27], v7 offset:18432
  s_waitcnt lgkmcnt(3)
  v_mfma_f32_32x32x16_bf16 v[32:47], v[28:31], a[28:31], v[32:47]
  v_exp_f32 v88, v88
  ds_read_b128 v[28:31], v7 offset:19456
  s_waitcnt lgkmcnt(3)
  v_mfma_f32_32x32x16_bf16 v[32:47], v[16:19], a[32:35], v[32:47]
  v_mul_f32 v64, v64, v72
  v_exp_f32 v89, v89
  ds_read_b128 v[16:19], v7 offset:20480
  s_waitcnt lgkmcnt(3)
  v_mfma_f32_32x32x16_bf16 v[32:47], v[20:23], a[36:39], v[32:47]
  v_mul_f32 v65, v65, v73
  v_exp_f32 v90, v90
  ds_read_b128 v[20:23], v7 offset:21504
  s_waitcnt lgkmcnt(3)
  v_mfma_f32_32x32x16_bf16 v[32:47], v[24:27], a[40:43], v[32:47]
  v_mul_f32 v66, v66, v74
  v_exp_f32 v91, v91
  ds_read_b128 v[24:27], v7 offset:22528
  s_waitcnt lgkmcnt(3)
  v_mfma_f32_32x32x16_bf16 v[32:47], v[28:31], a[44:47], v[32:47]
  v_mul_f32 v67, v67, v75
  v_exp_f32 v92, v92
  ds_read_b128 v[28:31], v7 offset:23552
  s_waitcnt lgkmcnt(3)
  v_mfma_f32_32x32x16_bf16 v[32:47], v[16:19], a[48:51], v[32:47]
  v_mul_f32 v68, v68, v76
  v_exp_f32 v93, v93
  ds_read_b128 v[16:19], v7 offset:24576
  s_waitcnt lgkmcnt(3)
  v_mfma_f32_32x32x16_bf16 v[32:47], v[20:23], a[52:55], v[32:47]
  v_mul_f32 v69, v69, v77
  v_exp_f32 v94, v94
  ds_read_b128 v[20:23], v7 offset:25600
  s_waitcnt lgkmcnt(3)
  v_mfma_f32_32x32x16_bf16 v[32:47], v[24:27], a[56:59], v[32:47]
  v_mul_f32 v70, v70, v78
  v_exp_f32 v95, v95
  ds_read_b128 v[24:27], v7 offset:26624
  s_waitcnt lgkmcnt(3)
  v_mfma_f32_32x32x16_bf16 v[32:47], v[28:31], a[60:63], v[32:47]
  v_mul_f32 v71, v71, v79
  v_fma_f32 v88, v88, v13, v13
  ds_read_b128 v[28:31], v7 offset:27648
  s_waitcnt lgkmcnt(3)
  v_mfma_f32_32x32x16_bf16 v[32:47], v[16:19], a[64:67], v[32:47]
  v_fma_f32 v89, v89, v13, v13
  v_fma_f32 v90, v90, v13, v13
  ds_read_b128 v[16:19], v7 offset:28672
  s_waitcnt lgkmcnt(3)
  v_mfma_f32_32x32x16_bf16 v[32:47], v[20:23], a[68:71], v[32:47]
  v_fma_f32 v91, v91, v13, v13
  v_fma_f32 v92, v92, v13, v13
  ds_read_b128 v[20:23], v7 offset:29696
  s_waitcnt lgkmcnt(3)
  v_mfma_f32_32x32x16_bf16 v[32:47], v[24:27], a[72:75], v[32:47]
  v_fma_f32 v93, v93, v13, v13
  v_fma_f32 v94, v94, v13, v13
  ds_read_b128 v[24:27], v7 offset:30720
  s_waitcnt lgkmcnt(3)
  v_mfma_f32_32x32x16_bf16 v[32:47], v[28:31], a[76:79], v[32:47]
  v_fma_f32 v95, v95, v13, v13
  v_rcp_f32 v88, v88
  ds_read_b128 v[28:31], v7 offset:31744
  s_waitcnt lgkmcnt(3)
  v_mfma_f32_32x32x16_bf16 v[32:47], v[16:19], a[80:83], v[32:47]
  v_rcp_f32 v89, v89
  ds_read_b128 v[16:19], v5 offset:0
  s_waitcnt lgkmcnt(3)
  v_mfma_f32_32x32x16_bf16 v[32:47], v[20:23], a[84:87], v[32:47]
  v_rcp_f32 v90, v90
  ds_read_b128 v[20:23], v5 offset:1024
  s_waitcnt lgkmcnt(3)
  v_mfma_f32_32x32x16_bf16 v[32:47], v[24:27], a[88:91], v[32:47]
  v_rcp_f32 v91, v91
  ds_read_b128 v[24:27], v5 offset:2048
  s_waitcnt lgkmcnt(3)
  v_mfma_f32_32x32x16_bf16 v[32:47], v[28:31], a[92:95], v[32:47]
  v_rcp_f32 v92, v92
  ds_read_b128 v[28:31], v5 offset:3072
  s_waitcnt lgkmcnt(3)
  v_mfma_f32_32x32x16_bf16 v[32:47], v[16:19], a[96:99], v[32:47]
  v_rcp_f32 v93, v93
  ds_read_b128 v[16:19], v5 offset:4096
  s_waitcnt lgkmcnt(3)
  v_mfma_f32_32x32x16_bf16 v[32:47], v[20:23], a[100:103], v[32:47]
  v_rcp_f32 v94, v94
  ds_read_b128 v[20:23], v5 offset:5120
  s_waitcnt lgkmcnt(3)
  v_mfma_f32_32x32x16_bf16 v[32:47], v[24:27], a[104:107], v[32:47]
  v_rcp_f32 v95, v95
  ds_read_b128 v[24:27], v5 offset:6144
  s_waitcnt lgkmcnt(3)
  v_mfma_f32_32x32x16_bf16 v[32:47], v[28:31], a[108:111], v[32:47]
  s_nop 0
  v_mul_f32 v64, v64, v88
  ds_read_b128 v[28:31], v5 offset:7168
  s_waitcnt lgkmcnt(3)
  v_mfma_f32_32x32x16_bf16 v[32:47], v[16:19], a[112:115], v[32:47]
  v_mul_f32 v65, v65, v89
  v_cvt_pk_bf16_f32 v84, v64, v65
  s_waitcnt lgkmcnt(2)
  v_mfma_f32_32x32x16_bf16 v[32:47], v[20:23], a[116:119], v[32:47]
  v_mul_f32 v66, v66, v90
  v_mul_f32 v67, v67, v91
  s_waitcnt lgkmcnt(1)
  v_mfma_f32_32x32x16_bf16 v[32:47], v[24:27], a[120:123], v[32:47]
  v_cvt_pk_bf16_f32 v85, v66, v67
  v_mul_f32 v68, v68, v92
  s_waitcnt lgkmcnt(0)
  v_mfma_f32_32x32x16_bf16 v[32:47], v[28:31], a[124:127], v[32:47]
  v_mul_f32 v69, v69, v93
  v_cvt_pk_bf16_f32 v86, v68, v69
  v_mul_f32 v70, v70, v94
  v_mul_f32 v71, v71, v95
  v_cvt_pk_bf16_f32 v87, v70, v71
  s_add_u32 s16, s16, 16384
  s_waitcnt vmcnt(0)
  s_add_u32 s31, s54, 5
  v_mov_b32 v14, s31
  s_mov_b64 exec, 1
  s_cmp_eq_u32 s44, 1
  s_cbranch_scc1 L_main_kernel_91
  buffer_store_dword v14, v127, s[36:39], s15 offen sc1
  s_branch L_main_kernel_92
L_main_kernel_91:
  buffer_store_dword v14, v127, s[36:39], s15 offen
L_main_kernel_92:
  s_mov_b64 exec, -1
  s_cmp_eq_u32 s44, 1
  s_cbranch_scc1 L_main_kernel_93
  buffer_store_dwordx4 v[84:87], v5, s[36:39], s16 offen sc1
  s_branch L_main_kernel_94
L_main_kernel_93:
  buffer_store_dwordx4 v[84:87], v5, s[36:39], s16 offen
L_main_kernel_94:
  v_mfma_f32_32x32x16_bf16 v[32:47], v[120:123], v[8:11], v[32:47]
  s_waitcnt lgkmcnt(0)
  s_barrier
  s_nop 9
  v_mul_f32 v88, v12, v32
  v_mul_f32 v89, v12, v33
  v_mul_f32 v90, v12, v34
  v_mul_f32 v91, v12, v35
  v_mul_f32 v92, v12, v36
  v_mul_f32 v93, v12, v37
  v_mul_f32 v94, v12, v38
  v_mul_f32 v95, v12, v39
  v_exp_f32 v88, v88
  v_mul_f32 v32, v32, v40
  v_exp_f32 v89, v89
  v_mul_f32 v33, v33, v41
  v_exp_f32 v90, v90
  v_mul_f32 v34, v34, v42
  v_exp_f32 v91, v91
  v_mul_f32 v35, v35, v43
  v_exp_f32 v92, v92
  v_mul_f32 v36, v36, v44
  v_exp_f32 v93, v93
  v_mul_f32 v37, v37, v45
  v_exp_f32 v94, v94
  v_mul_f32 v38, v38, v46
  v_exp_f32 v95, v95
  v_mul_f32 v39, v39, v47
  v_fma_f32 v88, v88, v13, v13
  v_fma_f32 v89, v89, v13, v13
  v_fma_f32 v90, v90, v13, v13
  v_fma_f32 v91, v91, v13, v13
  v_fma_f32 v92, v92, v13, v13
  v_fma_f32 v93, v93, v13, v13
  v_fma_f32 v94, v94, v13, v13
  v_fma_f32 v95, v95, v13, v13
  v_rcp_f32 v88, v88
  v_rcp_f32 v89, v89
  v_rcp_f32 v90, v90
  v_rcp_f32 v91, v91
  v_rcp_f32 v92, v92
  v_rcp_f32 v93, v93
  v_rcp_f32 v94, v94
  v_rcp_f32 v95, v95
  s_nop 0
  v_mul_f32 v32, v32, v88
  v_mul_f32 v33, v33, v89
  v_cvt_pk_bf16_f32 v80, v32, v33
  v_mul_f32 v34, v34, v90
  v_mul_f32 v35, v35, v91
  v_cvt_pk_bf16_f32 v81, v34, v35
  v_mul_f32 v36, v36, v92
  v_mul_f32 v37, v37, v93
  v_cvt_pk_bf16_f32 v82, v36, v37
  v_mul_f32 v38, v38, v94
  v_mul_f32 v39, v39, v95
  v_cvt_pk_bf16_f32 v83, v38, v39
  s_add_u32 s16, s16, 16384
  s_waitcnt vmcnt(0)
  s_add_u32 s31, s54, 6
  v_mov_b32 v14, s31
  s_mov_b64 exec, 1
  s_cmp_eq_u32 s44, 1
  s_cbranch_scc1 L_main_kernel_95
  buffer_store_dword v14, v127, s[36:39], s15 offen sc1
  s_branch L_main_kernel_96
L_main_kernel_95:
  buffer_store_dword v14, v127, s[36:39], s15 offen
L_main_kernel_96:
  s_mov_b64 exec, -1
  s_cmp_eq_u32 s44, 1
  s_cbranch_scc1 L_main_kernel_97
  buffer_store_dwordx4 v[80:83], v5, s[36:39], s16 offen sc1
  s_branch L_main_kernel_98
L_main_kernel_97:
  buffer_store_dwordx4 v[80:83], v5, s[36:39], s16 offen
L_main_kernel_98:
  s_add_u32 s31, s54, 7
  v_mov_b32 v14, s31
  s_waitcnt vmcnt(0)
  s_mov_b64 exec, 1
  s_cmp_eq_u32 s44, 1
  s_cbranch_scc1 L_main_kernel_99
  buffer_store_dword v14, v127, s[36:39], s15 offen sc1
  s_branch L_main_kernel_100
L_main_kernel_99:
  buffer_store_dword v14, v127, s[36:39], s15 offen
L_main_kernel_100:
  s_mov_b64 exec, -1
  s_branch RD_main_kernel_72
RL_main_kernel_71:
  s_lshl_b32 s10, s9, 11
  s_add_u32 s14, s10, 57344
  v_add_u32 v120, s14, v5
  s_lshl_b32 s11, s6, 13
  s_add_u32 s11, s11, s49
  s_mul_i32 s19, s7, 229376
  s_add_u32 s19, s19, s10
  s_add_u32 s19, s19, 0x80000
  s_mov_b32 exec_lo, 0xffff
  s_mov_b32 exec_hi, 0
  s_add_u32 s31, s54, 1
  s_mov_b32 s53, 0
L_main_kernel_101:
  buffer_load_dword v10, v125, s[36:39], s13 offen sc1
  s_add_u32 s53, s53, 1
  s_waitcnt vmcnt(0)
  v_subrev_u32 v10, s31, v10
  v_cmp_lt_u32 vcc, 15, v10
  s_cbranch_vccz L_main_kernel_102
  s_cmp_lt_u32 s53, 400000
  s_cbranch_scc1 L_main_kernel_101
L_main_kernel_102:
  s_mov_b64 exec, -1
  buffer_load_dwordx4 v[16:19], v5, s[36:39], s11 offen offset:0 sc1
  buffer_load_dwordx4 v[20:23], v5, s[36:39], s11 offen offset:1024 sc1
  buffer_load_dwordx4 v[24:27], v5, s[36:39], s11 offen offset:2048 sc1
  buffer_load_dwordx4 v[28:31], v5, s[36:39], s11 offen offset:3072 sc1
  s_add_u32 s11, s11, 4096
  buffer_load_dwordx4 v[32:35], v5, s[36:39], s11 offen offset:0 sc1
  buffer_load_dwordx4 v[36:39], v5, s[36:39], s11 offen offset:1024 sc1
  buffer_load_dwordx4 v[40:43], v5, s[36:39], s11 offen offset:2048 sc1
  buffer_load_dwordx4 v[44:47], v5, s[36:39], s11 offen offset:3072 sc1
  s_lshr_b32 s20, s5, 2
  s_lshl_b32 s20, s20, 1
  s_and_b32 s14, s9, 1
  s_add_u32 s20, s20, s14
  s_mul_i32 s20, s20, 114688
  s_lshr_b32 s14, s9, 1
  s_lshl_b32 s14, s14, 11
  s_add_u32 s20, s20, s14
  s_add_u32 s20, s20, 0x400000
  s_mul_i32 s16, s6, 112
  s_add_u32 s16, s16, s7
  s_lshl_b32 s16, s16, 10
  s_add_u32 s16, s16, 0x1c00000
  v_and_b32 v121, 7, v2
  v_lshlrev_b32 v121, 7, v121
  v_lshrrev_b32 v122, 3, v2
  v_lshl_add_u32 v121, v122, 14, v121
  s_waitcnt lgkmcnt(0)
  s_barrier
  s_waitcnt lgkmcnt(0)
  s_barrier
  s_waitcnt vmcnt(0)
  v_add_f32 v16, v16, v18
  v_add_f32 v17, v17, v19
  v_add_f32 v20, v20, v22
  v_add_f32 v21, v21, v23
  v_add_f32 v24, v24, v26
  v_add_f32 v25, v25, v27
  v_add_f32 v28, v28, v30
  v_add_f32 v29, v29, v31
  v_add_f32 v32, v32, v34
  v_add_f32 v33, v33, v35
  v_add_f32 v36, v36, v38
  v_add_f32 v37, v37, v39
  v_add_f32 v40, v40, v42
  v_add_f32 v41, v41, v43
  v_add_f32 v44, v44, v46
  v_add_f32 v45, v45, v47
  v_add_f32 v16, v16, v20
  v_add_f32 v17, v17, v21
  v_add_f32 v24, v24, v28
  v_add_f32 v25, v25, v29
  v_add_f32 v32, v32, v36
  v_add_f32 v33, v33, v37
  v_add_f32 v40, v40, v44
  v_add_f32 v41, v41, v45
  v_add_f32 v16, v16, v24
  v_add_f32 v17, v17, v25
  v_add_f32 v32, v32, v40
  v_add_f32 v33, v33, v41
  v_add_f32 v16, v16, v32
  v_add_f32 v17, v17, v33
  v_mov_b32 v10, v16
  v_mov_b32 v11, v17
  s_nop 1
  v_permlane32_swap_b32 v16, v10
  v_permlane32_swap_b32 v17, v11
  s_nop 1
  v_add_f32 v16, v16, v10
  v_add_f32 v17, v17, v11
  v_mul_f32 v8, 0xbb000000, v16
  v_mul_f32 v10, 0x3b000000, v17
  v_fma_f32 v10, -v8, v8, v10
  v_max_f32 v10, 0, v10
  v_add_f32 v13, 0x3727c5ac, v10
  v_rsq_f32 v14, v13
  v_cvt_pk_bf16_f32 v116, v8, v8
  v_lshlrev_b32 v10, 16, v116
  v_sub_f32 v10, v8, v10
  v_cvt_pk_bf16_f32 v117, v10, v10
  v_mov_b32 v118, v116
  v_mov_b32 v119, v117
  v_mul_f32 v12, 0xbfb8aa3b, v14
  ds_write_b128 v120, v[116:119]
  ds_write_b96 v120, v[12:14] offset:1024
  s_waitcnt lgkmcnt(0)
  s_barrier
  s_waitcnt lgkmcnt(0)
  s_barrier
  s_add_u32 m0, s10, 32768
  s_add_u32 s14, s19, 98304
  buffer_load_dwordx4 v5, s[36:39], s14 offen lds
  buffer_load_dwordx4 v5, s[36:39], s14 offen offset:1024 lds
  s_add_u32 m0, s10, 40960
  s_add_u32 s14, s19, 106496
  buffer_load_dwordx4 v5, s[36:39], s14 offen lds
  buffer_load_dwordx4 v5, s[36:39], s14 offen offset:1024 lds
  s_add_u32 m0, s10, 49152
  s_add_u32 s14, s19, 114688
  buffer_load_dwordx4 v5, s[36:39], s14 offen lds
  buffer_load_dwordx4 v5, s[36:39], s14 offen offset:1024 lds
  s_add_u32 m0, s10, 114688
  s_add_u32 s14, s19, 122880
  buffer_load_dwordx4 v5, s[36:39], s14 offen lds
  buffer_load_dwordx4 v5, s[36:39], s14 offen offset:1024 lds
  s_waitcnt lgkmcnt(0)
  s_barrier
  s_mov_b32 exec_lo, 0xffff
  s_mov_b32 exec_hi, 0
  buffer_load_dword v122, v121, s[36:39], s16 offen sc1
  s_mov_b64 exec, -1
  s_add_u32 s16, s16, 32768
  s_add_u32 m0, s10, 122880
  s_add_u32 s14, s19, 131072
  buffer_load_dwordx4 v5, s[36:39], s14 offen lds
  buffer_load_dwordx4 v5, s[36:39], s14 offen offset:1024 lds
  s_add_u32 m0, s10, 131072
  s_add_u32 s14, s19, 139264
  buffer_load_dwordx4 v5, s[36:39], s14 offen lds
  buffer_load_dwordx4 v5, s[36:39], s14 offen offset:1024 lds
  s_add_u32 m0, s10, 139264
  s_add_u32 s14, s19, 147456
  buffer_load_dwordx4 v5, s[36:39], s14 offen lds
  buffer_load_dwordx4 v5, s[36:39], s14 offen offset:1024 lds
  s_add_u32 m0, s10, 65536
  s_add_u32 s14, s19, 155648
  buffer_load_dwordx4 v5, s[36:39], s14 offen lds
  buffer_load_dwordx4 v5, s[36:39], s14 offen offset:1024 lds
  s_add_u32 s14, s20, 0
  buffer_load_dwordx4 a[0:3], v5, s[36:39], s14 offen offset:0
  buffer_load_dwordx4 a[4:7], v5, s[36:39], s14 offen offset:1024
  s_add_u32 s14, s20, 4096
  buffer_load_dwordx4 a[8:11], v5, s[36:39], s14 offen offset:0
  buffer_load_dwordx4 a[12:15], v5, s[36:39], s14 offen offset:1024
  s_waitcnt vmcnt(19)
  s_waitcnt vmcnt(17)
  s_waitcnt vmcnt(15)
  s_waitcnt vmcnt(13)
  s_waitcnt lgkmcnt(0)
  s_barrier
  s_mov_b32 exec_lo, 0xffff
  s_mov_b32 exec_hi, 0
  buffer_load_dword v122, v121, s[36:39], s16 offen sc1
  s_mov_b64 exec, -1
  s_add_u32 s16, s16, 32768
  s_add_u32 m0, s10, 73728
  s_add_u32 s14, s19, 163840
  buffer_load_dwordx4 v5, s[36:39], s14 offen lds
  buffer_load_dwordx4 v5, s[36:39], s14 offen offset:1024 lds
  s_add_u32 m0, s10, 81920
  s_add_u32 s14, s19, 172032
  buffer_load_dwordx4 v5, s[36:39], s14 offen lds
  buffer_load_dwordx4 v5, s[36:39], s14 offen offset:1024 lds
  s_add_u32 m0, s10, 90112
  s_add_u32 s14, s19, 180224
  buffer_load_dwordx4 v5, s[36:39], s14 offen lds
  buffer_load_dwordx4 v5, s[36:39], s14 offen offset:1024 lds
  s_add_u32 m0, s10, 98304
  s_add_u32 s14, s19, 188416
  buffer_load_dwordx4 v5, s[36:39], s14 offen lds
  buffer_load_dwordx4 v5, s[36:39], s14 offen offset:1024 lds
  s_add_u32 s14, s20, 8192
  buffer_load_dwordx4 a[16:19], v5, s[36:39], s14 offen offset:0
  buffer_load_dwordx4 a[20:23], v5, s[36:39], s14 offen offset:1024
  s_add_u32 s14, s20, 12288
  buffer_load_dwordx4 a[24:27], v5, s[36:39], s14 offen offset:0
  buffer_load_dwordx4 a[28:31], v5, s[36:39], s14 offen offset:1024
  s_waitcnt vmcnt(23)
  s_waitcnt vmcnt(21)
  s_waitcnt vmcnt(19)
  s_waitcnt vmcnt(17)
  s_waitcnt lgkmcnt(0)
  s_barrier
  s_mov_b32 exec_lo, 0xffff
  s_mov_b32 exec_hi, 0
  buffer_load_dword v122, v121, s[36:39], s16 offen sc1
  s_mov_b64 exec, -1
  s_add_u32 s16, s16, 32768
  s_add_u32 m0, s10, 106496
  s_add_u32 s14, s19, 196608
  buffer_load_dwordx4 v5, s[36:39], s14 offen lds
  buffer_load_dwordx4 v5, s[36:39], s14 offen offset:1024 lds
  s_add_u32 m0, s10, 147456
  s_add_u32 s14, s19, 204800
  buffer_load_dwordx4 v5, s[36:39], s14 offen lds
  buffer_load_dwordx4 v5, s[36:39], s14 offen offset:1024 lds
  s_add_u32 m0, s10, 155648
  s_add_u32 s14, s19, 212992
  buffer_load_dwordx4 v5, s[36:39], s14 offen lds
  buffer_load_dwordx4 v5, s[36:39], s14 offen offset:1024 lds
  s_add_u32 m0, s10, 0
  s_add_u32 s14, s19, 221184
  buffer_load_dwordx4 v5, s[36:39], s14 offen lds
  buffer_load_dwordx4 v5, s[36:39], s14 offen offset:1024 lds
  s_add_u32 s14, s20, 16384
  buffer_load_dwordx4 a[32:35], v5, s[36:39], s14 offen offset:0
  buffer_load_dwordx4 a[36:39], v5, s[36:39], s14 offen offset:1024
  s_add_u32 s14, s20, 20480
  buffer_load_dwordx4 a[40:43], v5, s[36:39], s14 offen offset:0
  buffer_load_dwordx4 a[44:47], v5, s[36:39], s14 offen offset:1024
  s_add_u32 s14, s20, 24576
  buffer_load_dwordx4 a[48:51], v5, s[36:39], s14 offen offset:0
  s_waitcnt vmcnt(24)
  s_waitcnt vmcnt(22)
  s_waitcnt vmcnt(20)
  s_waitcnt vmcnt(18)
  s_waitcnt lgkmcnt(0)
  s_barrier
  s_mov_b32 exec_lo, 0xff
  s_mov_b32 exec_hi, 0
  buffer_load_dword v122, v121, s[36:39], s16 offen sc1
  s_mov_b64 exec, -1
  s_add_u32 s16, s16, 32768
  s_add_u32 s14, s20, 24576
  buffer_load_dwordx4 a[52:55], v5, s[36:39], s14 offen offset:1024
  s_add_u32 s14, s20, 28672
  buffer_load_dwordx4 a[56:59], v5, s[36:39], s14 offen offset:0
  buffer_load_dwordx4 a[60:63], v5, s[36:39], s14 offen offset:1024
  s_add_u32 s14, s20, 32768
  buffer_load_dwordx4 a[64:67], v5, s[36:39], s14 offen offset:0
  buffer_load_dwordx4 a[68:71], v5, s[36:39], s14 offen offset:1024
  s_add_u32 s14, s20, 36864
  buffer_load_dwordx4 a[72:75], v5, s[36:39], s14 offen offset:0
  buffer_load_dwordx4 a[76:79], v5, s[36:39], s14 offen offset:1024
  s_add_u32 s14, s20, 40960
  buffer_load_dwordx4 a[80:83], v5, s[36:39], s14 offen offset:0
  buffer_load_dwordx4 a[84:87], v5, s[36:39], s14 offen offset:1024
  s_waitcnt vmcnt(21)
  s_waitcnt vmcnt(19)
  s_waitcnt vmcnt(17)
  s_waitcnt vmcnt(15)
  s_waitcnt lgkmcnt(0)
  s_barrier
  s_and_b32 s13, s5, 3
  s_lshl_b32 s14, s4, 2
  s_add_u32 s14, s14, s13
  s_lshl_b32 s13, s13, 7
  s_add_u32 s13, s13, s47
  s_add_u32 s13, s13, 2048
  s_lshl_b32 s14, s14, 1
  s_lshr_b32 s15, s9, 1
  s_add_u32 s14, s14, s15
  s_mul_i32 s19, s14, 114688
  s_and_b32 s14, s10, 2048
  s_add_u32 s19, s19, s14
  s_add_u32 s19, s19, 0x1c00000
  s_mov_b32 exec_lo, 0xffffffff
  s_mov_b32 exec_hi, 0
  s_add_u32 s31, s54, 2
  s_mov_b32 s53, 0
L_main_kernel_103:
  buffer_load_dword v10, v125, s[36:39], s13 offen sc1
  s_add_u32 s53, s53, 1
  s_waitcnt vmcnt(0)
  v_subrev_u32 v10, s31, v10
  v_cmp_lt_u32 vcc, 15, v10
  s_cbranch_vccz L_main_kernel_104
  s_cmp_lt_u32 s53, 400000
  s_cbranch_scc1 L_main_kernel_103
L_main_kernel_104:
  s_mov_b64 exec, -1
  s_add_u32 m0, s10, 32768
  s_add_u32 s14, s19, 0
  buffer_load_dwordx4 v5, s[36:39], s14 offen sc1 lds
  buffer_load_dwordx4 v5, s[36:39], s14 offen offset:1024 sc1 lds
  s_add_u32 m0, s10, 40960
  s_add_u32 s14, s19, 4096
  buffer_load_dwordx4 v5, s[36:39], s14 offen sc1 lds
  buffer_load_dwordx4 v5, s[36:39], s14 offen offset:1024 sc1 lds
  s_add_u32 m0, s10, 49152
  s_add_u32 s14, s19, 8192
  buffer_load_dwordx4 v5, s[36:39], s14 offen sc1 lds
  buffer_load_dwordx4 v5, s[36:39], s14 offen offset:1024 sc1 lds
  s_add_u32 m0, s10, 57344
  s_add_u32 s14, s19, 12288
  buffer_load_dwordx4 v5, s[36:39], s14 offen sc1 lds
  buffer_load_dwordx4 v5, s[36:39], s14 offen offset:1024 sc1 lds
  s_add_u32 m0, s10, 114688
  s_add_u32 s14, s19, 16384
  buffer_load_dwordx4 v5, s[36:39], s14 offen sc1 lds
  buffer_load_dwordx4 v5, s[36:39], s14 offen offset:1024 sc1 lds
  s_add_u32 m0, s10, 122880
  s_add_u32 s14, s19, 20480
  buffer_load_dwordx4 v5, s[36:39], s14 offen sc1 lds
  buffer_load_dwordx4 v5, s[36:39], s14 offen offset:1024 sc1 lds
  s_add_u32 s14, s20, 45056
  buffer_load_dwordx4 a[88:91], v5, s[36:39], s14 offen offset:0
  buffer_load_dwordx4 a[92:95], v5, s[36:39], s14 offen offset:1024
  s_add_u32 s14, s20, 49152
  buffer_load_dwordx4 a[96:99], v5, s[36:39], s14 offen offset:0
  buffer_load_dwordx4 a[100:103], v5, s[36:39], s14 offen offset:1024
  s_add_u32 s14, s20, 53248
  buffer_load_dwordx4 a[104:107], v5, s[36:39], s14 offen offset:0
  buffer_load_dwordx4 a[108:111], v5, s[36:39], s14 offen offset:1024
  s_add_u32 s14, s20, 57344
  buffer_load_dwordx4 a[112:115], v5, s[36:39], s14 offen offset:0
  buffer_load_dwordx4 a[116:119], v5, s[36:39], s14 offen offset:1024
  s_barrier
RD_main_kernel_72:
  s_and_b32 s22, s5, 3
  s_lshl_b32 s8, s4, 2
  s_add_u32 s6, s22, s8
  s_lshr_b32 s7, s5, 2
  s_lshl_b32 s13, s22, 7
  s_add_u32 s13, s13, s47
  s_add_u32 s13, s13, 2048
  s_and_b32 s17, s3, 3
  s_cmp_ge_u32 s3, 4
  s_cbranch_scc0 GL_main_kernel_105
  s_lshr_b32 s8, s17, 1
  s_and_b32 s9, s17, 1
  s_lshl_b32 s10, s6, 1
  s_add_u32 s10, s10, s8
  s_lshl_b32 s12, s7, 1
  s_add_u32 s12, s12, s9
  s_mul_i32 s11, s12, 114688
  s_lshl_b32 s14, s8, 11
  s_add_u32 s11, s11, s14
  s_add_u32 s11, s11, 0x400000
  s_lshl_b32 s20, s10, 15
  s_lshl_b32 s21, s12, 11
  s_add_u32 s20, s20, s21
  s_add_u32 s20, s20, s46
  buffer_load_dwordx4 v[8:11], v5, s[36:39], s20 offen sc1
  buffer_load_dwordx4 v[12:15], v5, s[36:39], s20 offen offset:1024 sc1
  s_add_u32 s14, s11, 61440
  buffer_load_dwordx4 a[120:123], v5, s[36:39], s14 offen offset:0
  s_add_u32 s14, s11, 61440
  buffer_load_dwordx4 a[124:127], v5, s[36:39], s14 offen offset:1024
  s_add_u32 s14, s11, 65536
  buffer_load_dwordx4 v[72:75], v5, s[36:39], s14 offen offset:0
  s_add_u32 s14, s11, 65536
  buffer_load_dwordx4 v[76:79], v5, s[36:39], s14 offen offset:1024
  s_add_u32 s14, s11, 69632
  buffer_load_dwordx4 v[80:83], v5, s[36:39], s14 offen offset:0
  s_add_u32 s14, s11, 69632
  buffer_load_dwordx4 v[84:87], v5, s[36:39], s14 offen offset:1024
  s_add_u32 s14, s11, 73728
  buffer_load_dwordx4 v[88:91], v5, s[36:39], s14 offen offset:0
  s_add_u32 s14, s11, 73728
  buffer_load_dwordx4 v[92:95], v5, s[36:39], s14 offen offset:1024
  s_add_u32 s14, s11, 77824
  buffer_load_dwordx4 v[96:99], v5, s[36:39], s14 offen offset:0
  s_add_u32 s14, s11, 77824
  buffer_load_dwordx4 v[100:103], v5, s[36:39], s14 offen offset:1024
  s_add_u32 s14, s11, 81920
  buffer_load_dwordx4 v[104:107], v5, s[36:39], s14 offen offset:0
  s_add_u32 s14, s11, 81920
  buffer_load_dwordx4 v[108:111], v5, s[36:39], s14 offen offset:1024
  s_mul_i32 s14, s8, 6144
  s_xor_b32 s15, s8, 1
  s_lshl_b32 s15, s15, 12
  s_lshl_b32 s16, s8, 11
  s_add_u32 s15, s15, s16
  v_add_u32 v112, s14, v5
  v_add_u32 v116, s15, v5
  v_add_u32 v113, s14, v6
  v_add_u32 v117, s15, v6
  v_add_u32 v114, s14, v7
  v_add_u32 v118, s15, v7
  s_lshl_b32 s21, s10, 13
  s_lshl_b32 s16, s7, 10
  s_add_u32 s21, s21, s16
  s_lshl_b32 s16, s9, 3
  s_add_u32 s21, s21, s16
  s_add_u32 s21, s21, s49
  s_and_b32 s23, s10, 7
  s_lshl_b32 s23, s23, 6
  s_lshl_b32 s16, s12, 2
  s_add_u32 s23, s23, s16
  s_add_u32 s23, s23, s50
  s_add_u32 s23, s23, 1024
  s_xor_b32 s16, s17, 2
  s_lshl_b32 s16, s16, 12
  v_add_u32 v120, s16, v5
  s_lshl_b32 s16, s17, 12
  v_add_u32 v121, s16, v5
  s_mov_b32 s16, 0x3f803f80
  s_waitcnt vmcnt(12)
  v_lshlrev_b32 v16, 16, v8
  v_and_b32 v17, 0xffff0000, v8
  v_lshlrev_b32 v18, 16, v9
  v_and_b32 v19, 0xffff0000, v9
  v_lshlrev_b32 v20, 16, v10
  v_and_b32 v21, 0xffff0000, v10
  v_lshlrev_b32 v22, 16, v11
  v_and_b32 v23, 0xffff0000, v11
  v_lshlrev_b32 v24, 16, v12
  v_and_b32 v25, 0xffff0000, v12
  v_lshlrev_b32 v26, 16, v13
  v_and_b32 v27, 0xffff0000, v13
  v_lshlrev_b32 v28, 16, v14
  v_and_b32 v29, 0xffff0000, v14
  v_lshlrev_b32 v30, 16, v15
  v_and_b32 v31, 0xffff0000, v15
  s_waitcnt lgkmcnt(0)
  s_barrier
  ds_read_b128 v[48:51], v112 offset:32768
  ds_read_b128 v[52:55], v116 offset:32768
  ds_read_b128 v[56:59], v112 offset:33792
  ds_read_b128 v[60:63], v116 offset:33792
  ds_read_b128 v[64:67], v112 offset:40960
  ds_read_b128 v[68:71], v116 offset:40960
  s_waitcnt lgkmcnt(4)
  v_mfma_f32_32x32x16_bf16 v[16:31], a[0:3], v[48:51], v[16:31]
  v_mfma_f32_32x32x16_bf16 v[32:47], a[0:3], v[52:55], 0
  s_add_u32 s14, s11, 86016
  buffer_load_dwordx4 a[0:3], v5, s[36:39], s14 offen offset:0
  ds_read_b128 v[48:51], v112 offset:41984
  ds_read_b128 v[52:55], v116 offset:41984
  s_waitcnt lgkmcnt(4)
  v_mfma_f32_32x32x16_bf16 v[16:31], a[4:7], v[56:59], v[16:31]
  v_mfma_f32_32x32x16_bf16 v[32:47], a[4:7], v[60:63], v[32:47]
  s_add_u32 s14, s11, 86016
  buffer_load_dwordx4 a[4:7], v5, s[36:39], s14 offen offset:1024
  s_waitcnt lgkmcnt(0)
  s_barrier
  ds_read_b128 v[56:59], v112 offset:49152
  ds_read_b128 v[60:63], v116 offset:49152
  v_mfma_f32_32x32x16_bf16 v[16:31], a[8:11], v[64:67], v[16:31]
  v_mfma_f32_32x32x16_bf16 v[32:47], a[8:11], v[68:71], v[32:47]
  s_add_u32 s14, s11, 90112
  buffer_load_dwordx4 a[8:11], v5, s[36:39], s14 offen offset:0
  ds_read_b128 v[64:67], v112 offset:50176
  ds_read_b128 v[68:71], v116 offset:50176
  v_mfma_f32_32x32x16_bf16 v[16:31], a[12:15], v[48:51], v[16:31]
  v_mfma_f32_32x32x16_bf16 v[32:47], a[12:15], v[52:55], v[32:47]
  s_add_u32 s14, s11, 90112
  buffer_load_dwordx4 a[12:15], v5, s[36:39], s14 offen offset:1024
  ds_read_b128 v[48:51], v112 offset:57344
  ds_read_b128 v[52:55], v116 offset:57344
  s_waitcnt lgkmcnt(4)
  v_mfma_f32_32x32x16_bf16 v[16:31], a[16:19], v[56:59], v[16:31]
  v_mfma_f32_32x32x16_bf16 v[32:47], a[16:19], v[60:63], v[32:47]
  s_add_u32 s14, s11, 94208
  buffer_load_dwordx4 a[16:19], v5, s[36:39], s14 offen offset:0
  ds_read_b128 v[56:59], v112 offset:58368
  ds_read_b128 v[60:63], v116 offset:58368
  s_waitcnt lgkmcnt(4)
  v_mfma_f32_32x32x16_bf16 v[16:31], a[20:23], v[64:67], v[16:31]
  v_mfma_f32_32x32x16_bf16 v[32:47], a[20:23], v[68:71], v[32:47]
  s_add_u32 s14, s11, 94208
  buffer_load_dwordx4 a[20:23], v5, s[36:39], s14 offen offset:1024
  s_waitcnt lgkmcnt(0)
  s_barrier
  ds_read_b128 v[64:67], v113 offset:49152
  ds_read_b128 v[68:71], v117 offset:49152
  v_mfma_f32_32x32x16_bf16 v[16:31], a[24:27], v[48:51], v[16:31]
  v_mfma_f32_32x32x16_bf16 v[32:47], a[24:27], v[52:55], v[32:47]
  s_add_u32 s14, s11, 98304
  buffer_load_dwordx4 a[24:27], v5, s[36:39], s14 offen offset:0
  ds_read_b128 v[48:51], v113 offset:50176
  ds_read_b128 v[52:55], v117 offset:50176
  v_mfma_f32_32x32x16_bf16 v[16:31], a[28:31], v[56:59], v[16:31]
  v_mfma_f32_32x32x16_bf16 v[32:47], a[28:31], v[60:63], v[32:47]
  s_add_u32 s14, s11, 98304
  buffer_load_dwordx4 a[28:31], v5, s[36:39], s14 offen offset:1024
  ds_read_b128 v[56:59], v113 offset:57344
  ds_read_b128 v[60:63], v117 offset:57344
  s_waitcnt lgkmcnt(4)
  v_mfma_f32_32x32x16_bf16 v[16:31], a[32:35], v[64:67], v[16:31]
  v_mfma_f32_32x32x16_bf16 v[32:47], a[32:35], v[68:71], v[32:47]
  s_add_u32 s14, s11, 102400
  buffer_load_dwordx4 a[32:35], v5, s[36:39], s14 offen offset:0
  ds_read_b128 v[64:67], v113 offset:58368
  ds_read_b128 v[68:71], v117 offset:58368
  s_waitcnt lgkmcnt(4)
  v_mfma_f32_32x32x16_bf16 v[16:31], a[36:39], v[48:51], v[16:31]
  v_mfma_f32_32x32x16_bf16 v[32:47], a[36:39], v[52:55], v[32:47]
  s_add_u32 s14, s11, 102400
  buffer_load_dwordx4 a[36:39], v5, s[36:39], s14 offen offset:1024
  s_waitcnt lgkmcnt(0)
  s_barrier
  ds_read_b128 v[48:51], v114 offset:0
  ds_read_b128 v[52:55], v118 offset:0
  v_mfma_f32_32x32x16_bf16 v[16:31], a[40:43], v[56:59], v[16:31]
  v_mfma_f32_32x32x16_bf16 v[32:47], a[40:43], v[60:63], v[32:47]
  s_add_u32 s14, s11, 106496
  buffer_load_dwordx4 a[40:43], v5, s[36:39], s14 offen offset:0
  ds_read_b128 v[56:59], v114 offset:1024
  ds_read_b128 v[60:63], v118 offset:1024
  v_mfma_f32_32x32x16_bf16 v[16:31], a[44:47], v[64:67], v[16:31]
  v_mfma_f32_32x32x16_bf16 v[32:47], a[44:47], v[68:71], v[32:47]
  s_add_u32 s14, s11, 106496
  buffer_load_dwordx4 a[44:47], v5, s[36:39], s14 offen offset:1024
  ds_read_b128 v[64:67], v114 offset:8192
  ds_read_b128 v[68:71], v118 offset:8192
  s_waitcnt lgkmcnt(4)
  v_mfma_f32_32x32x16_bf16 v[16:31], a[48:51], v[48:51], v[16:31]
  v_mfma_f32_32x32x16_bf16 v[32:47], a[48:51], v[52:55], v[32:47]
  s_add_u32 s14, s11, 110592
  buffer_load_dwordx4 a[48:51], v5, s[36:39], s14 offen offset:0
  ds_read_b128 v[48:51], v114 offset:9216
  ds_read_b128 v[52:55], v118 offset:9216
  s_waitcnt lgkmcnt(4)
  v_mfma_f32_32x32x16_bf16 v[16:31], a[52:55], v[56:59], v[16:31]
  v_mfma_f32_32x32x16_bf16 v[32:47], a[52:55], v[60:63], v[32:47]
  s_add_u32 s14, s11, 110592
  buffer_load_dwordx4 a[52:55], v5, s[36:39], s14 offen offset:1024
  s_mov_b32 exec_lo, 0xffffffff
  s_mov_b32 exec_hi, 0
  s_add_u32 s31, s54, 7
  s_mov_b32 s53, 0
L_main_kernel_107:
  buffer_load_dword v122, v125, s[36:39], s13 offen sc1
  s_add_u32 s53, s53, 1
  s_waitcnt vmcnt(0)
  v_subrev_u32 v122, s31, v122
  v_cmp_lt_u32 vcc, 15, v122
  s_cbranch_vccz L_main_kernel_108
  s_cmp_lt_u32 s53, 400000
  s_cbranch_scc1 L_main_kernel_107
L_main_kernel_108:
  s_mov_b64 exec, -1
  s_waitcnt lgkmcnt(0)
  s_barrier
  ds_read_b128 v[56:59], v112 offset:0
  ds_read_b128 v[60:63], v116 offset:0
  v_mfma_f32_32x32x16_bf16 v[16:31], a[56:59], v[64:67], v[16:31]
  v_mfma_f32_32x32x16_bf16 v[32:47], a[56:59], v[68:71], v[32:47]
  ds_read_b128 v[64:67], v112 offset:1024
  ds_read_b128 v[68:71], v116 offset:1024
  v_mfma_f32_32x32x16_bf16 v[16:31], a[60:63], v[48:51], v[16:31]
  v_mfma_f32_32x32x16_bf16 v[32:47], a[60:63], v[52:55], v[32:47]
  ds_read_b128 v[48:51], v112 offset:8192
  ds_read_b128 v[52:55], v116 offset:8192
  s_waitcnt lgkmcnt(4)
  v_mfma_f32_32x32x16_bf16 v[16:31], a[64:67], v[56:59], v[16:31]
  v_mfma_f32_32x32x16_bf16 v[32:47], a[64:67], v[60:63], v[32:47]
  ds_read_b128 v[56:59], v112 offset:9216
  ds_read_b128 v[60:63], v116 offset:9216
  s_waitcnt lgkmcnt(4)
  v_mfma_f32_32x32x16_bf16 v[16:31], a[68:71], v[64:67], v[16:31]
  v_mfma_f32_32x32x16_bf16 v[32:47], a[68:71], v[68:71], v[32:47]
  s_waitcnt lgkmcnt(0)
  s_barrier
  ds_read_b128 v[64:67], v112 offset:16384
  ds_read_b128 v[68:71], v116 offset:16384
  v_mfma_f32_32x32x16_bf16 v[16:31], a[72:75], v[48:51], v[16:31]
  v_mfma_f32_32x32x16_bf16 v[32:47], a[72:75], v[52:55], v[32:47]
  ds_read_b128 v[48:51], v112 offset:17408
  ds_read_b128 v[52:55], v116 offset:17408
  v_mfma_f32_32x32x16_bf16 v[16:31], a[76:79], v[56:59], v[16:31]
  v_mfma_f32_32x32x16_bf16 v[32:47], a[76:79], v[60:63], v[32:47]
  ds_read_b128 v[56:59], v112 offset:24576
  ds_read_b128 v[60:63], v116 offset:24576
  s_waitcnt lgkmcnt(4)
  v_mfma_f32_32x32x16_bf16 v[16:31], a[80:83], v[64:67], v[16:31]
  v_mfma_f32_32x32x16_bf16 v[32:47], a[80:83], v[68:71], v[32:47]
  ds_read_b128 v[64:67], v112 offset:25600
  ds_read_b128 v[68:71], v116 offset:25600
  s_waitcnt lgkmcnt(4)
  v_mfma_f32_32x32x16_bf16 v[16:31], a[84:87], v[48:51], v[16:31]
  v_mfma_f32_32x32x16_bf16 v[32:47], a[84:87], v[52:55], v[32:47]
  s_waitcnt lgkmcnt(0)
  s_barrier
  ds_read_b128 v[48:51], v112 offset:32768
  ds_read_b128 v[52:55], v116 offset:32768
  v_mfma_f32_32x32x16_bf16 v[16:31], a[88:91], v[56:59], v[16:31]
  v_mfma_f32_32x32x16_bf16 v[32:47], a[88:91], v[60:63], v[32:47]
  ds_read_b128 v[56:59], v112 offset:33792
  ds_read_b128 v[60:63], v116 offset:33792
  v_mfma_f32_32x32x16_bf16 v[16:31], a[92:95], v[64:67], v[16:31]
  v_mfma_f32_32x32x16_bf16 v[32:47], a[92:95], v[68:71], v[32:47]
  ds_read_b128 v[64:67], v112 offset:40960
  ds_read_b128 v[68:71], v116 offset:40960
  s_waitcnt lgkmcnt(4)
  v_mfma_f32_32x32x16_bf16 v[16:31], a[96:99], v[48:51], v[16:31]
  v_mfma_f32_32x32x16_bf16 v[32:47], a[96:99], v[52:55], v[32:47]
  ds_read_b128 v[48:51], v112 offset:41984
  ds_read_b128 v[52:55], v116 offset:41984
  s_waitcnt lgkmcnt(4)
  v_mfma_f32_32x32x16_bf16 v[16:31], a[100:103], v[56:59], v[16:31]
  v_mfma_f32_32x32x16_bf16 v[32:47], a[100:103], v[60:63], v[32:47]
  s_waitcnt lgkmcnt(0)
  s_barrier
  ds_read_b128 v[56:59], v112 offset:49152
  ds_read_b128 v[60:63], v116 offset:49152
  v_mfma_f32_32x32x16_bf16 v[16:31], a[104:107], v[64:67], v[16:31]
  v_mfma_f32_32x32x16_bf16 v[32:47], a[104:107], v[68:71], v[32:47]
  ds_read_b128 v[64:67], v112 offset:50176
  ds_read_b128 v[68:71], v116 offset:50176
  v_mfma_f32_32x32x16_bf16 v[16:31], a[108:111], v[48:51], v[16:31]
  v_mfma_f32_32x32x16_bf16 v[32:47], a[108:111], v[52:55], v[32:47]
  ds_read_b128 v[48:51], v112 offset:57344
  ds_read_b128 v[52:55], v116 offset:57344
  s_waitcnt lgkmcnt(4)
  v_mfma_f32_32x32x16_bf16 v[16:31], a[112:115], v[56:59], v[16:31]
  v_mfma_f32_32x32x16_bf16 v[32:47], a[112:115], v[60:63], v[32:47]
  ds_read_b128 v[56:59], v112 offset:58368
  ds_read_b128 v[60:63], v116 offset:58368
  s_waitcnt lgkmcnt(4)
  v_mfma_f32_32x32x16_bf16 v[16:31], a[116:119], v[64:67], v[16:31]
  v_mfma_f32_32x32x16_bf16 v[32:47], a[116:119], v[68:71], v[32:47]
  s_waitcnt lgkmcnt(0)
  s_barrier
  ds_read_b128 v[64:67], v113 offset:49152
  ds_read_b128 v[68:71], v117 offset:49152
  v_mfma_f32_32x32x16_bf16 v[16:31], a[120:123], v[48:51], v[16:31]
  v_mfma_f32_32x32x16_bf16 v[32:47], a[120:123], v[52:55], v[32:47]
  ds_read_b128 v[48:51], v113 offset:50176
  ds_read_b128 v[52:55], v117 offset:50176
  v_mfma_f32_32x32x16_bf16 v[16:31], a[124:127], v[56:59], v[16:31]
  v_mfma_f32_32x32x16_bf16 v[32:47], a[124:127], v[60:63], v[32:47]
  ds_read_b128 v[56:59], v113 offset:57344
  ds_read_b128 v[60:63], v117 offset:57344
  s_waitcnt lgkmcnt(4)
  v_mfma_f32_32x32x16_bf16 v[16:31], v[72:75], v[64:67], v[16:31]
  v_mfma_f32_32x32x16_bf16 v[32:47], v[72:75], v[68:71], v[32:47]
  ds_read_b128 v[64:67], v113 offset:58368
  ds_read_b128 v[68:71], v117 offset:58368
  s_waitcnt lgkmcnt(4)
  v_mfma_f32_32x32x16_bf16 v[16:31], v[76:79], v[48:51], v[16:31]
  v_mfma_f32_32x32x16_bf16 v[32:47], v[76:79], v[52:55], v[32:47]
  s_waitcnt lgkmcnt(0)
  s_barrier
  ds_read_b128 v[48:51], v114 offset:0
  ds_read_b128 v[52:55], v118 offset:0
  v_mfma_f32_32x32x16_bf16 v[16:31], v[80:83], v[56:59], v[16:31]
  v_mfma_f32_32x32x16_bf16 v[32:47], v[80:83], v[60:63], v[32:47]
  ds_read_b128 v[56:59], v114 offset:1024
  ds_read_b128 v[60:63], v118 offset:1024
  v_mfma_f32_32x32x16_bf16 v[16:31], v[84:87], v[64:67], v[16:31]
  v_mfma_f32_32x32x16_bf16 v[32:47], v[84:87], v[68:71], v[32:47]
  ds_read_b128 v[64:67], v114 offset:8192
  ds_read_b128 v[68:71], v118 offset:8192
  s_waitcnt lgkmcnt(4)
  v_mfma_f32_32x32x16_bf16 v[16:31], v[88:91], v[48:51], v[16:31]
  v_mfma_f32_32x32x16_bf16 v[32:47], v[88:91], v[52:55], v[32:47]
  ds_read_b128 v[48:51], v114 offset:9216
  ds_read_b128 v[52:55], v118 offset:9216
  s_waitcnt lgkmcnt(4)
  v_mfma_f32_32x32x16_bf16 v[16:31], v[92:95], v[56:59], v[16:31]
  v_mfma_f32_32x32x16_bf16 v[32:47], v[92:95], v[60:63], v[32:47]
  s_waitcnt lgkmcnt(0)
  s_barrier
  ds_read_b128 v[56:59], v112 offset:0
  ds_read_b128 v[60:63], v116 offset:0
  v_mfma_f32_32x32x16_bf16 v[16:31], v[96:99], v[64:67], v[16:31]
  v_mfma_f32_32x32x16_bf16 v[32:47], v[96:99], v[68:71], v[32:47]
  ds_read_b128 v[64:67], v112 offset:1024
  ds_read_b128 v[68:71], v116 offset:1024
  v_mfma_f32_32x32x16_bf16 v[16:31], v[100:103], v[48:51], v[16:31]
  v_mfma_f32_32x32x16_bf16 v[32:47], v[100:103], v[52:55], v[32:47]
  ds_read_b128 v[48:51], v112 offset:8192
  ds_read_b128 v[52:55], v116 offset:8192
  s_waitcnt lgkmcnt(4)
  v_mfma_f32_32x32x16_bf16 v[16:31], v[104:107], v[56:59], v[16:31]
  v_mfma_f32_32x32x16_bf16 v[32:47], v[104:107], v[60:63], v[32:47]
  ds_read_b128 v[56:59], v112 offset:9216
  ds_read_b128 v[60:63], v116 offset:9216
  s_waitcnt lgkmcnt(4)
  v_mfma_f32_32x32x16_bf16 v[16:31], v[108:111], v[64:67], v[16:31]
  v_mfma_f32_32x32x16_bf16 v[32:47], v[108:111], v[68:71], v[32:47]
  s_waitcnt lgkmcnt(0)
  s_barrier
  ds_read_b128 v[64:67], v112 offset:16384
  ds_read_b128 v[68:71], v116 offset:16384
  v_mfma_f32_32x32x16_bf16 v[16:31], a[0:3], v[48:51], v[16:31]
  v_mfma_f32_32x32x16_bf16 v[32:47], a[0:3], v[52:55], v[32:47]
  ds_read_b128 v[48:51], v112 offset:17408
  ds_read_b128 v[52:55], v116 offset:17408
  v_mfma_f32_32x32x16_bf16 v[16:31], a[4:7], v[56:59], v[16:31]
  v_mfma_f32_32x32x16_bf16 v[32:47], a[4:7], v[60:63], v[32:47]
  ds_read_b128 v[56:59], v112 offset:24576
  ds_read_b128 v[60:63], v116 offset:24576
  s_waitcnt lgkmcnt(4)
  v_mfma_f32_32x32x16_bf16 v[16:31], a[8:11], v[64:67], v[16:31]
  v_mfma_f32_32x32x16_bf16 v[32:47], a[8:11], v[68:71], v[32:47]
  ds_read_b128 v[64:67], v112 offset:25600
  ds_read_b128 v[68:71], v116 offset:25600
  s_waitcnt lgkmcnt(4)
  v_mfma_f32_32x32x16_bf16 v[16:31], a[12:15], v[48:51], v[16:31]
  v_mfma_f32_32x32x16_bf16 v[32:47], a[12:15], v[52:55], v[32:47]
  s_waitcnt lgkmcnt(0)
  s_barrier
  ds_read_b128 v[48:51], v112 offset:32768
  ds_read_b128 v[52:55], v116 offset:32768
  v_mfma_f32_32x32x16_bf16 v[16:31], a[16:19], v[56:59], v[16:31]
  v_mfma_f32_32x32x16_bf16 v[32:47], a[16:19], v[60:63], v[32:47]
  ds_read_b128 v[56:59], v112 offset:33792
  ds_read_b128 v[60:63], v116 offset:33792
  v_mfma_f32_32x32x16_bf16 v[16:31], a[20:23], v[64:67], v[16:31]
  v_mfma_f32_32x32x16_bf16 v[32:47], a[20:23], v[68:71], v[32:47]
  ds_read_b128 v[64:67], v112 offset:40960
  ds_read_b128 v[68:71], v116 offset:40960
  s_waitcnt lgkmcnt(4)
  v_mfma_f32_32x32x16_bf16 v[16:31], a[24:27], v[48:51], v[16:31]
  v_mfma_f32_32x32x16_bf16 v[32:47], a[24:27], v[52:55], v[32:47]
  ds_read_b128 v[48:51], v112 offset:41984
  ds_read_b128 v[52:55], v116 offset:41984
  s_waitcnt lgkmcnt(4)
  v_mfma_f32_32x32x16_bf16 v[16:31], a[28:31], v[56:59], v[16:31]
  v_mfma_f32_32x32x16_bf16 v[32:47], a[28:31], v[60:63], v[32:47]
  s_waitcnt lgkmcnt(0)
  s_barrier
  ds_read_b128 v[56:59], v112 offset:49152
  ds_read_b128 v[60:63], v116 offset:49152
  v_mfma_f32_32x32x16_bf16 v[16:31], a[32:35], v[64:67], v[16:31]
  v_mfma_f32_32x32x16_bf16 v[32:47], a[32:35], v[68:71], v[32:47]
  ds_read_b128 v[64:67], v112 offset:50176
  ds_read_b128 v[68:71], v116 offset:50176
  v_mfma_f32_32x32x16_bf16 v[16:31], a[36:39], v[48:51], v[16:31]
  v_mfma_f32_32x32x16_bf16 v[32:47], a[36:39], v[52:55], v[32:47]
  ds_read_b128 v[48:51], v112 offset:57344
  ds_read_b128 v[52:55], v116 offset:57344
  s_waitcnt lgkmcnt(4)
  v_mfma_f32_32x32x16_bf16 v[16:31], a[40:43], v[56:59], v[16:31]
  v_mfma_f32_32x32x16_bf16 v[32:47], a[40:43], v[60:63], v[32:47]
  ds_read_b128 v[56:59], v112 offset:58368
  ds_read_b128 v[60:63], v116 offset:58368
  s_waitcnt lgkmcnt(4)
  v_mfma_f32_32x32x16_bf16 v[16:31], a[44:47], v[64:67], v[16:31]
  v_mfma_f32_32x32x16_bf16 v[32:47], a[44:47], v[68:71], v[32:47]
  s_waitcnt lgkmcnt(2)
  v_mfma_f32_32x32x16_bf16 v[16:31], a[48:51], v[48:51], v[16:31]
  v_mfma_f32_32x32x16_bf16 v[32:47], a[48:51], v[52:55], v[32:47]
  s_waitcnt lgkmcnt(0)
  v_mfma_f32_32x32x16_bf16 v[16:31], a[52:55], v[56:59], v[16:31]
  v_mfma_f32_32x32x16_bf16 v[32:47], a[52:55], v[60:63], v[32:47]
  s_barrier
  s_nop 11
  ds_write_b128 v120, v[32:35] offset:32768
  ds_write_b128 v120, v[36:39] offset:33792
  ds_write_b128 v120, v[40:43] offset:34816
  ds_write_b128 v120, v[44:47] offset:35840
  s_waitcnt lgkmcnt(0)
  s_barrier
  ds_read_b128 v[32:35], v121 offset:32768
  ds_read_b128 v[36:39], v121 offset:33792
  ds_read_b128 v[40:43], v121 offset:34816
  ds_read_b128 v[44:47], v121 offset:35840
  s_waitcnt lgkmcnt(3)
  v_add_f32 v16, v16, v32
  v_add_f32 v17, v17, v33
  v_add_f32 v18, v18, v34
  v_add_f32 v19, v19, v35
  s_waitcnt lgkmcnt(2)
  v_add_f32 v20, v20, v36
  v_add_f32 v21, v21, v37
  v_add_f32 v22, v22, v38
  v_add_f32 v23, v23, v39
  s_waitcnt lgkmcnt(1)
  v_add_f32 v24, v24, v40
  v_add_f32 v25, v25, v41
  v_add_f32 v26, v26, v42
  v_add_f32 v27, v27, v43
  s_waitcnt lgkmcnt(0)
  v_add_f32 v28, v28, v44
  v_add_f32 v29, v29, v45
  v_add_f32 v30, v30, v46
  v_add_f32 v31, v31, v47
  s_barrier
  v_cvt_pk_bf16_f32 v8, v16, v17
  v_cvt_pk_bf16_f32 v9, v18, v19
  v_cvt_pk_bf16_f32 v10, v20, v21
  v_cvt_pk_bf16_f32 v11, v22, v23
  v_cvt_pk_bf16_f32 v12, v24, v25
  v_cvt_pk_bf16_f32 v13, v26, v27
  v_cvt_pk_bf16_f32 v14, v28, v29
  v_cvt_pk_bf16_f32 v15, v30, v31
  s_cmp_eq_u32 s48, 1
  s_cbranch_scc1 L_main_kernel_109
  s_cmp_eq_u32 s44, 1
  s_cbranch_scc1 L_main_kernel_110
  buffer_store_dwordx4 v[8:11], v5, s[36:39], s20 offen sc1
  buffer_store_dwordx4 v[12:15], v5, s[36:39], s20 offen offset:1024 sc1
  s_branch L_main_kernel_111
L_main_kernel_110:
  buffer_store_dwordx4 v[8:11], v5, s[36:39], s20 offen
  buffer_store_dwordx4 v[12:15], v5, s[36:39], s20 offen offset:1024
L_main_kernel_111:
  v_mov_b32 v122, 0
  v_mov_b32 v123, 0
  v_dot2_f32_bf16 v122, v8, s16, v122
  v_dot2_f32_bf16 v123, v8, v8, v123
  v_dot2_f32_bf16 v122, v9, s16, v122
  v_dot2_f32_bf16 v123, v9, v9, v123
  v_dot2_f32_bf16 v122, v10, s16, v122
  v_dot2_f32_bf16 v123, v10, v10, v123
  v_dot2_f32_bf16 v122, v11, s16, v122
  v_dot2_f32_bf16 v123, v11, v11, v123
  v_dot2_f32_bf16 v122, v12, s16, v122
  v_dot2_f32_bf16 v123, v12, v12, v123
  v_dot2_f32_bf16 v122, v13, s16, v122
  v_dot2_f32_bf16 v123, v13, v13, v123
  v_dot2_f32_bf16 v122, v14, s16, v122
  v_dot2_f32_bf16 v123, v14, v14, v123
  v_dot2_f32_bf16 v122, v15, s16, v122
  v_dot2_f32_bf16 v123, v15, v15, v123
  s_nop 2
  s_cmp_eq_u32 s44, 1
  s_cbranch_scc1 L_main_kernel_112
  buffer_store_dwordx2 v[122:123], v5, s[36:39], s21 offen sc1
  s_branch L_main_kernel_113
L_main_kernel_112:
  buffer_store_dwordx2 v[122:123], v5, s[36:39], s21 offen
L_main_kernel_113:
  s_waitcnt vmcnt(0)
  s_mov_b64 exec, 1
  s_cmp_eq_u32 s44, 1
  s_cbranch_scc1 L_main_kernel_114
  buffer_store_dword v126, v127, s[36:39], s23 offen sc1
  s_branch L_main_kernel_115
L_main_kernel_114:
  buffer_store_dword v126, v127, s[36:39], s23 offen
L_main_kernel_115:
  s_mov_b64 exec, -1
  s_branch GD_main_kernel_106
L_main_kernel_109:
  v_lshlrev_b32 v122, 10, v3
  v_lshl_add_u32 v122, v4, 4, v122
  s_lshl_b32 s21, s10, 15
  s_lshl_b32 s16, s12, 6
  s_add_u32 s21, s21, s16
  v_permlane32_swap_b32 v8, v10
  v_permlane32_swap_b32 v9, v11
  v_permlane32_swap_b32 v12, v14
  v_permlane32_swap_b32 v13, v15
  s_nop 1
  buffer_store_dwordx4 v[8:11], v122, s[40:43], s21 offen offset:0
  buffer_store_dwordx4 v[12:15], v122, s[40:43], s21 offen offset:32
  s_branch GD_main_kernel_106
GL_main_kernel_105:
  s_mov_b32 s9, s17
  s_lshr_b32 s8, s9, 1
  s_and_b32 s12, s9, 1
  s_lshl_b32 s10, s9, 11
  s_lshl_b32 s12, s12, 11
  s_lshl_b32 s11, s6, 1
  s_add_u32 s11, s11, s8
  s_mul_i32 s11, s11, 114688
  s_add_u32 s11, s11, s12
  s_add_u32 s11, s11, 0x1c00000
  s_lshr_b32 s15, s5, 1
  s_mul_i32 s15, s15, 98304
  s_add_u32 s15, s15, s10
  s_add_u32 s15, s15, 0x3400000
  s_add_u32 s15, s15, s55
  s_mov_b32 exec_lo, 0xffffffff
  s_mov_b32 exec_hi, 0
  s_add_u32 s31, s54, 5
  s_mov_b32 s53, 0
L_main_kernel_116:
  buffer_load_dword v8, v125, s[36:39], s13 offen sc1
  s_add_u32 s53, s53, 1
  s_waitcnt vmcnt(0)
  v_subrev_u32 v8, s31, v8
  v_cmp_lt_u32 vcc, 15, v8
  s_cbranch_vccz L_main_kernel_117
  s_cmp_lt_u32 s53, 400000
  s_cbranch_scc1 L_main_kernel_116
L_main_kernel_117:
  s_mov_b64 exec, -1
  s_add_u32 m0, s10, 131072
  s_add_u32 s8, s11, 24576
  buffer_load_dwordx4 v5, s[36:39], s8 offen sc1 lds
  buffer_load_dwordx4 v5, s[36:39], s8 offen offset:1024 sc1 lds
  s_add_u32 m0, s10, 139264
  s_add_u32 s8, s11, 28672
  buffer_load_dwordx4 v5, s[36:39], s8 offen sc1 lds
  buffer_load_dwordx4 v5, s[36:39], s8 offen offset:1024 sc1 lds
  s_add_u32 m0, s10, 0
  s_add_u32 s8, s11, 32768
  buffer_load_dwordx4 v5, s[36:39], s8 offen sc1 lds
  buffer_load_dwordx4 v5, s[36:39], s8 offen offset:1024 sc1 lds
  s_add_u32 m0, s10, 8192
  s_add_u32 s8, s11, 36864
  buffer_load_dwordx4 v5, s[36:39], s8 offen sc1 lds
  buffer_load_dwordx4 v5, s[36:39], s8 offen offset:1024 sc1 lds
  s_add_u32 m0, s10, 16384
  s_add_u32 s8, s11, 40960
  buffer_load_dwordx4 v5, s[36:39], s8 offen sc1 lds
  buffer_load_dwordx4 v5, s[36:39], s8 offen offset:1024 sc1 lds
  s_add_u32 m0, s10, 24576
  s_add_u32 s8, s11, 45056
  buffer_load_dwordx4 v5, s[36:39], s8 offen sc1 lds
  buffer_load_dwordx4 v5, s[36:39], s8 offen offset:1024 sc1 lds
  s_barrier
  s_barrier
  s_add_u32 m0, s10, 32768
  s_add_u32 s8, s11, 49152
  buffer_load_dwordx4 v5, s[36:39], s8 offen sc1 lds
  buffer_load_dwordx4 v5, s[36:39], s8 offen offset:1024 sc1 lds
  s_add_u32 m0, s10, 40960
  s_add_u32 s8, s11, 53248
  buffer_load_dwordx4 v5, s[36:39], s8 offen sc1 lds
  buffer_load_dwordx4 v5, s[36:39], s8 offen offset:1024 sc1 lds
  s_barrier
  s_add_u32 m0, s10, 49152
  s_add_u32 s8, s11, 57344
  buffer_load_dwordx4 v5, s[36:39], s8 offen sc1 lds
  buffer_load_dwordx4 v5, s[36:39], s8 offen offset:1024 sc1 lds
  s_add_u32 m0, s10, 57344
  s_add_u32 s8, s11, 61440
  buffer_load_dwordx4 v5, s[36:39], s8 offen sc1 lds
  buffer_load_dwordx4 v5, s[36:39], s8 offen offset:1024 sc1 lds
  s_waitcnt vmcnt(18)
  s_waitcnt vmcnt(16)
  s_barrier
  s_add_u32 m0, s10, 114688
  s_add_u32 s8, s11, 65536
  buffer_load_dwordx4 v5, s[36:39], s8 offen sc1 lds
  buffer_load_dwordx4 v5, s[36:39], s8 offen offset:1024 sc1 lds
  s_add_u32 m0, s10, 122880
  s_add_u32 s8, s11, 69632
  buffer_load_dwordx4 v5, s[36:39], s8 offen sc1 lds
  buffer_load_dwordx4 v5, s[36:39], s8 offen offset:1024 sc1 lds
  s_waitcnt vmcnt(18)
  s_waitcnt vmcnt(16)
  s_barrier
  s_add_u32 m0, s10, 131072
  s_add_u32 s8, s11, 73728
  buffer_load_dwordx4 v5, s[36:39], s8 offen sc1 lds
  buffer_load_dwordx4 v5, s[36:39], s8 offen offset:1024 sc1 lds
  s_add_u32 m0, s10, 139264
  s_add_u32 s8, s11, 77824
  buffer_load_dwordx4 v5, s[36:39], s8 offen sc1 lds
  buffer_load_dwordx4 v5, s[36:39], s8 offen offset:1024 sc1 lds
  s_waitcnt vmcnt(18)
  s_waitcnt vmcnt(16)
  s_barrier
  s_add_u32 m0, s10, 0
  s_add_u32 s8, s11, 81920
  buffer_load_dwordx4 v5, s[36:39], s8 offen sc1 lds
  buffer_load_dwordx4 v5, s[36:39], s8 offen offset:1024 sc1 lds
  s_add_u32 m0, s10, 8192
  s_add_u32 s8, s11, 86016
  buffer_load_dwordx4 v5, s[36:39], s8 offen sc1 lds
  buffer_load_dwordx4 v5, s[36:39], s8 offen offset:1024 sc1 lds
  s_waitcnt vmcnt(18)
  s_waitcnt vmcnt(16)
  s_barrier
  s_add_u32 m0, s10, 16384
  s_add_u32 s8, s11, 90112
  buffer_load_dwordx4 v5, s[36:39], s8 offen sc1 lds
  buffer_load_dwordx4 v5, s[36:39], s8 offen offset:1024 sc1 lds
  s_add_u32 m0, s10, 24576
  s_add_u32 s8, s11, 94208
  buffer_load_dwordx4 v5, s[36:39], s8 offen sc1 lds
  buffer_load_dwordx4 v5, s[36:39], s8 offen offset:1024 sc1 lds
  s_waitcnt vmcnt(18)
  s_waitcnt vmcnt(16)
  s_barrier
  s_add_u32 m0, s10, 32768
  s_add_u32 s8, s11, 98304
  buffer_load_dwordx4 v5, s[36:39], s8 offen sc1 lds
  buffer_load_dwordx4 v5, s[36:39], s8 offen offset:1024 sc1 lds
  s_add_u32 m0, s10, 40960
  s_add_u32 s8, s11, 102400
  buffer_load_dwordx4 v5, s[36:39], s8 offen sc1 lds
  buffer_load_dwordx4 v5, s[36:39], s8 offen offset:1024 sc1 lds
  s_waitcnt vmcnt(18)
  s_waitcnt vmcnt(16)
  s_barrier
  s_add_u32 m0, s10, 49152
  s_add_u32 s8, s11, 106496
  buffer_load_dwordx4 v5, s[36:39], s8 offen sc1 lds
  buffer_load_dwordx4 v5, s[36:39], s8 offen offset:1024 sc1 lds
  s_add_u32 m0, s10, 57344
  s_add_u32 s8, s11, 110592
  buffer_load_dwordx4 v5, s[36:39], s8 offen sc1 lds
  buffer_load_dwordx4 v5, s[36:39], s8 offen offset:1024 sc1 lds
  s_cmp_eq_u32 s48, 1
  s_cbranch_scc1 L_main_kernel_118
  s_add_u32 m0, s10, 65536
  s_add_u32 s14, s15, 32768
  buffer_load_dwordx4 v5, s[36:39], s14 offen lds
  buffer_load_dwordx4 v5, s[36:39], s14 offen offset:1024 lds
  s_add_u32 m0, s10, 73728
  s_add_u32 s14, s15, 65536
  buffer_load_dwordx4 v5, s[36:39], s14 offen lds
  buffer_load_dwordx4 v5, s[36:39], s14 offen offset:1024 lds
  s_add_u32 m0, s10, 81920
  s_add_u32 s14, s15, 40960
  buffer_load_dwordx4 v5, s[36:39], s14 offen lds
  buffer_load_dwordx4 v5, s[36:39], s14 offen offset:1024 lds
  s_waitcnt vmcnt(24)
  s_waitcnt vmcnt(22)
  s_barrier
  s_add_u32 m0, s10, 90112
  s_add_u32 s14, s15, 73728
  buffer_load_dwordx4 v5, s[36:39], s14 offen lds
  buffer_load_dwordx4 v5, s[36:39], s14 offen offset:1024 lds
  s_add_u32 m0, s10, 98304
  s_add_u32 s14, s15, 49152
  buffer_load_dwordx4 v5, s[36:39], s14 offen lds
  buffer_load_dwordx4 v5, s[36:39], s14 offen offset:1024 lds
  s_add_u32 m0, s10, 106496
  s_add_u32 s14, s15, 81920
  buffer_load_dwordx4 v5, s[36:39], s14 offen lds
  buffer_load_dwordx4 v5, s[36:39], s14 offen offset:1024 lds
  s_waitcnt vmcnt(26)
  s_waitcnt vmcnt(24)
  s_barrier
  s_add_u32 m0, s10, 147456
  s_add_u32 s14, s15, 57344
  buffer_load_dwordx4 v5, s[36:39], s14 offen lds
  buffer_load_dwordx4 v5, s[36:39], s14 offen offset:1024 lds
  s_add_u32 m0, s10, 155648
  s_add_u32 s14, s15, 90112
  buffer_load_dwordx4 v5, s[36:39], s14 offen lds
  buffer_load_dwordx4 v5, s[36:39], s14 offen offset:1024 lds
  s_waitcnt vmcnt(26)
  s_waitcnt vmcnt(24)
  s_barrier
  s_add_u32 m0, s10, 0
  s_add_u32 s14, s15, 0
  buffer_load_dwordx4 v5, s[36:39], s14 offen lds
  buffer_load_dwordx4 v5, s[36:39], s14 offen offset:1024 lds
  s_add_u32 m0, s10, 8192
  s_add_u32 s14, s15, 8192
  buffer_load_dwordx4 v5, s[36:39], s14 offen lds
  buffer_load_dwordx4 v5, s[36:39], s14 offen offset:1024 lds
  s_waitcnt vmcnt(26)
  s_waitcnt vmcnt(24)
  s_barrier
  s_add_u32 m0, s10, 16384
  s_add_u32 s14, s15, 16384
  buffer_load_dwordx4 v5, s[36:39], s14 offen lds
  buffer_load_dwordx4 v5, s[36:39], s14 offen offset:1024 lds
  s_add_u32 m0, s10, 24576
  s_add_u32 s14, s15, 24576
  buffer_load_dwordx4 v5, s[36:39], s14 offen lds
  buffer_load_dwordx4 v5, s[36:39], s14 offen offset:1024 lds
  s_waitcnt vmcnt(26)
  s_waitcnt vmcnt(24)
  s_barrier
  s_barrier
  s_barrier
  s_barrier
  s_branch L_main_kernel_119
L_main_kernel_118:
  s_waitcnt vmcnt(18)
  s_waitcnt vmcnt(16)
  s_barrier
  s_waitcnt vmcnt(14)
  s_waitcnt vmcnt(12)
  s_barrier
  s_waitcnt vmcnt(10)
  s_waitcnt vmcnt(8)
  s_barrier
  s_waitcnt vmcnt(6)
  s_waitcnt vmcnt(4)
  s_barrier
  s_waitcnt vmcnt(2)
  s_waitcnt vmcnt(0)
  s_barrier
  s_barrier
  s_barrier
  s_barrier
L_main_kernel_119:
GD_main_kernel_106:
  s_add_u32 s48, s48, 1
  s_add_u32 s45, s45, 0x1100000
  s_add_u32 s47, s47, 2560
  s_add_u32 s50, s50, 1024
  s_cmp_lt_u32 s48, 2
  s_cbranch_scc1 L_layer
L_main_end:
  s_endpgm
.section .rodata,"a"
.p2align 6
.amdhsa_kernel main_kernel
  .amdhsa_next_free_vgpr 256
  .amdhsa_next_free_sgpr 102
  .amdhsa_accum_offset 128
  .amdhsa_group_segment_fixed_size 0
  .amdhsa_kernarg_size 80
  .amdhsa_user_sgpr_count 2
  .amdhsa_user_sgpr_kernarg_segment_ptr 1
  .amdhsa_system_sgpr_workgroup_id_x 1
.end_amdhsa_kernel
```
